```python
import torch

def _softmax(x, axis=-1):
    return torch.softmax(x, dim=axis)
def _gelu(x):
    return torch.nn.functional.gelu(x, approximate="tanh")
def _silu(x):
    return torch.nn.functional.silu(x)
def _sigmoid(x):
    return torch.sigmoid(x)
def _layernorm(x, axis=-1, eps=1e-5):
    m = x.mean(dim=axis, keepdim=True)
    v = x.var(dim=axis, keepdim=True, unbiased=False)
    return (x - m) / torch.sqrt(v + eps)
def _scatter_add(tgt, idx, src, axis=0):
    return tgt.clone().index_add_(axis, idx, src)
def _segment_sum(src, seg, n):
    out = torch.zeros((n,) + src.shape[1:], dtype=src.dtype)
    return out.index_add_(0, seg, src)
def _pad(x, pw):
    flat = tuple(v for pair in reversed(pw) for v in pair)
    return torch.nn.functional.pad(x, flat)

kernel_name = 'concat_heads__ssm_conv_s5__grouped_kv_mqa__prompt'

def setup_inputs():

    _w = (lambda a: (lambda t: t.to(torch.bfloat16) if t.is_floating_point() else t)(torch.as_tensor(a)))
    def _A_setup():
        B, S, D = 1, 2048, 576
        P = D
        Lambda_re = -0.5 * (lambda _x: torch.exp(torch.as_tensor(_x)))((lambda *s: torch.randn(*s, dtype=torch.bfloat16) * 0.2)(P))
        Lambda_im = (lambda *s: torch.randn(*s, dtype=torch.bfloat16) * 0.4)(P) * 1.0
        B_re = (lambda *s: torch.randn(*s, dtype=torch.bfloat16) * 0.2)(P, D) * (D ** -0.5)
        B_im = (lambda *s: torch.randn(*s, dtype=torch.bfloat16) * 0.2)(P, D) * (D ** -0.5)
        C_re = (lambda *s: torch.randn(*s, dtype=torch.bfloat16) * 0.2)(D, P) * (P ** -0.5)
        C_im = (lambda *s: torch.randn(*s, dtype=torch.bfloat16) * 0.2)(D, P) * (P ** -0.5)
        log_dt = (lambda *s: torch.randn(*s, dtype=torch.bfloat16) * 0.2)(P) * 0.3 - 2.0
        Dskip = (lambda *s: torch.randn(*s, dtype=torch.bfloat16) * 0.05)(D)
        return {
            "x": _w((lambda *s: torch.randn(*s, dtype=torch.bfloat16) * 0.05)(B, S, D)),
            "Lambda_re": _w(Lambda_re),
            "Lambda_im": _w(Lambda_im),
            "B_re": _w(B_re),
            "B_im": _w(B_im),
            "C_re": _w(C_re),
            "C_im": _w(C_im),
            "log_dt": _w(log_dt),
            "Dskip": _w(Dskip),
        }
    _A_in = _A_setup()

    def _B_setup():
        B, S, D, H = 1, 2048, 576, 32
        Dh = D // H
        return {
            "x": _w((lambda *s: torch.randn(*s, dtype=torch.bfloat16) * 0.05)(B, S, D)),
            "wq": _w((lambda *s: torch.randn(*s, dtype=torch.bfloat16) * 0.8)(D, H * Dh)),
            "wk": _w((lambda *s: torch.randn(*s, dtype=torch.bfloat16) * 0.8)(D, Dh)),
            "wv": _w((lambda *s: torch.randn(*s, dtype=torch.bfloat16) * 0.05)(D, Dh)),
            "wo": _w((lambda *s: torch.randn(*s, dtype=torch.bfloat16) * 0.05)(H * Dh, D)),
        }
    _B_in = _B_setup()

    return {
        "A_x": _A_in["x"],
        "A_Lambda_re": _A_in["Lambda_re"],
        "A_Lambda_im": _A_in["Lambda_im"],
        "A_B_re": _A_in["B_re"],
        "A_B_im": _A_in["B_im"],
        "A_C_re": _A_in["C_re"],
        "A_C_im": _A_in["C_im"],
        "A_log_dt": _A_in["log_dt"],
        "A_Dskip": _A_in["Dskip"],
        "B_x": _B_in["x"],
        "B_wq": _B_in["wq"],
        "B_wk": _B_in["wk"],
        "B_wv": _B_in["wv"],
        "B_wo": _B_in["wo"],
    }

def reference(A_x, A_Lambda_re, A_Lambda_im, A_B_re, A_B_im, A_C_re, A_C_im, A_log_dt, A_Dskip, B_x, B_wq, B_wk, B_wv, B_wo):
    def _A_ref(x, Lambda_re, Lambda_im, B_re, B_im, C_re, C_im, log_dt, Dskip):
        Bsz, L, H = x.shape
        Lam = Lambda_re + 1j * Lambda_im
        Bmat = B_re + 1j * B_im
        Cmat = C_re + 1j * C_im
        dt = torch.exp(log_dt)
        Lam_bar = torch.exp(dt * Lam)
        B_bar = ((Lam_bar - 1.0) / Lam)[:, None] * Bmat
        Bu = torch.einsum("bld,pd->blp", x + 0j, B_bar)
        h = torch.zeros_like(Bu[:, 0, :])
        hs = []
        for t in range(L):
            h = Lam_bar[None, :] * h + Bu[:, t, :]
            hs.append(h)
        hseq = torch.stack(hs, 1)
        y = 2.0 * torch.einsum("blp,dp->bld", hseq, Cmat).real + x * Dskip[None, None, :]
        return y

    def _B_ref(x, wq, wk, wv, wo):
        B, S, D = x.shape
        H = 32
        Dh = D // H
        q = (lambda x, *d: x.permute(*d))((x @ wq).reshape(B, S, H, Dh), 0, 2, 1, 3)
        k = x @ wk
        v = x @ wv
        scores = torch.einsum("bhqd,bkd->bhqk", q, k) * (Dh ** -0.5)
        p = _softmax(scores, axis=-1)
        o = torch.einsum("bhqk,bkd->bhqd", p, v)
        return (lambda x, *d: x.permute(*d))(o, 0, 2, 1, 3).reshape(B, S, H * Dh) @ wo

    a = _A_ref(A_x, A_Lambda_re, A_Lambda_im, A_B_re, A_B_im, A_C_re, A_C_im, A_log_dt, A_Dskip)
    b = _B_ref(B_x, B_wq, B_wk, B_wv, B_wo)
    return torch.concatenate([a, b], axis=-1)
```

```asm
; @launch kernel=k1_kernel grid=(256,1,1) block=(512,1,1) lds=133120
; @launch kernel=k2_kernel grid=(256,1,1) block=(512,1,1) lds=163216
.amdgcn_target "amdgcn-amd-amdhsa--gfx950"
.text
.globl k1_kernel
.p2align 8
.type k1_kernel,@function
k1_kernel:
s_cmp_ge_u32 s2, 256
s_cbranch_scc1 k1_kernel_end
s_getpc_b64 s[50:51]
v_lshlrev_b32 v162, 4, v0
global_load_dwordx4 v[164:167], v162, s[50:51]
s_load_dwordx16 s[16:31], s[0:1], 0
s_load_dwordx16 s[32:47], s[0:1], 64
s_load_dwordx2 s[48:49], s[0:1], 128
v_lshrrev_b32 v1, 6, v0
v_and_b32 v0, 63, v0
v_readfirstlane_b32 s3, v1
s_and_b32 s4, s2, 7
s_lshl_b32 s4, s4, 1
s_bfe_u32 s5, s2, 0x10003
s_add_u32 s4, s4, s5
s_lshr_b32 s5, s2, 4
s_sub_u32 s7, s5, 9
s_and_b32 s6, s3, 3
s_cmp_lt_u32 s3, 4
s_cbranch_scc1 k1_comp
s_cmp_ge_u32 s5, 9
s_cbranch_scc1 k1_ld12
v_lshrrev_b32 v10, 3, v0
v_lshrrev_b32 v11, 4, v0
s_and_b32 s61, s6, 1
s_lshl_b32 s61, s61, 2
v_add_u32 v11, s61, v11
v_and_b32 v2, 7, v0
v_xor_b32 v2, v2, v11
v_lshlrev_b32 v2, 4, v2
v_lshrrev_b32 v11, 2, v10
v_lshlrev_b32 v11, 5, v11
v_and_b32 v10, 3, v10
v_add_u32 v10, v10, v11
s_mul_i32 s61, s6, 4
v_add_u32 v10, s61, v10
v_mul_u32_u24 v10, 1152, v10
v_add_u32 v2, v2, v10
s_mul_i32 s54, s4, 147456
v_lshrrev_b32 v10, 3, v0
v_lshrrev_b32 v11, 4, v0
s_and_b32 s61, s6, 1
s_lshl_b32 s61, s61, 2
v_add_u32 v11, s61, v11
v_and_b32 v3, 7, v0
v_xor_b32 v3, v3, v11
v_lshlrev_b32 v3, 4, v3
s_mul_i32 s61, s6, 8
v_add_u32 v10, s61, v10
v_mul_u32_u24 v10, 1152, v10
v_add_u32 v3, v3, v10
s_mul_i32 s55, s5, 73728
s_lshl_b32 s62, s6, 10
s_waitcnt lgkmcnt(0)
s_mov_b32 s64, s16
s_and_b32 s65, s17, 0xffff
s_mov_b32 s66, 2359296
s_mov_b32 s67, 0x20000
s_mov_b32 s68, s22
s_and_b32 s69, s23, 0xffff
s_mov_b32 s70, 663552
s_mov_b32 s71, 0x20000
s_mov_b32 s72, s24
s_and_b32 s73, s25, 0xffff
s_mov_b32 s74, 663552
s_mov_b32 s75, 0x20000
s_and_b32 s56, s2, 7
s_lshr_b32 s59, s2, 3
s_add_u32 s56, s56, s59
s_and_b32 s56, s56, 7
s_mul_i32 s59, s56, 128
s_add_u32 s54, s54, s59
s_mul_i32 s59, s56, 128
s_add_u32 s55, s55, s59
s_mov_b32 s57, 0
s_mov_b32 s58, 0
k1_t3_lp:
s_cmp_lt_u32 s57, 3
s_cbranch_scc1 k1_t3_lnw
s_waitcnt vmcnt(16)
s_barrier
k1_t3_lnw:
s_mov_b32 m0, s62
s_nop 0
buffer_load_dwordx4 v2, s[64:67], s54 offen lds
s_add_u32 m0, s62, 4096
s_add_u32 s60, s54, 18432
buffer_load_dwordx4 v2, s[64:67], s60 offen lds
s_add_u32 m0, s62, 8192
s_add_u32 s60, s54, 73728
buffer_load_dwordx4 v2, s[64:67], s60 offen lds
s_add_u32 m0, s62, 12288
s_add_u32 s60, s54, 92160
buffer_load_dwordx4 v2, s[64:67], s60 offen lds
s_add_u32 m0, s62, 16384
s_nop 0
buffer_load_dwordx4 v3, s[68:71], s55 offen lds
s_add_u32 m0, s62, 20480
s_add_u32 s60, s55, 36864
buffer_load_dwordx4 v3, s[68:71], s60 offen lds
s_add_u32 m0, s62, 24576
s_nop 0
buffer_load_dwordx4 v3, s[72:75], s55 offen lds
s_add_u32 m0, s62, 28672
s_add_u32 s60, s55, 36864
buffer_load_dwordx4 v3, s[72:75], s60 offen lds
s_add_u32 s54, s54, 128
s_add_u32 s55, s55, 128
s_add_u32 s57, s57, 1
s_add_u32 s58, s58, 1
s_cmp_eq_u32 s58, 4
s_cselect_b32 s58, 0, s58
s_mov_b32 s59, 32768
s_cselect_b32 s59, 4294868992, s59
s_add_u32 s62, s62, s59
s_add_u32 s56, s56, 1
s_cmp_lg_u32 s56, 9
s_cbranch_scc1 k1_t3_nw
s_sub_u32 s54, s54, 1152
s_sub_u32 s55, s55, 1152
k1_t3_nw:
s_cmp_lt_u32 s57, 9
s_cbranch_scc1 k1_t3_lp
s_mov_b32 s64, s42
s_and_b32 s65, s43, 0xffff
s_mov_b32 s66, 663552
s_mov_b32 s67, 0x20000
s_add_u32 s68, s48, 16125952
s_addc_u32 s69, s49, 0
s_and_b32 s69, s69, 0xffff
s_mov_b32 s70, 663552
s_mov_b32 s71, 0x20000
s_lshl_b32 s54, s2, 2
s_add_u32 s54, s54, s6
v_and_b32 v20, 31, v0
v_lshlrev_b32 v20, 1, v20
v_lshrrev_b32 v21, 5, v0
s_mul_i32 s55, s54, 1821
s_lshr_b32 s55, s55, 16
s_mul_i32 s56, s55, 36
s_sub_u32 s56, s54, s56
s_mul_i32 s58, s56, 18
s_mul_i32 s59, s56, 144
s_sub_u32 s59, s59, 4592
s_cmp_lt_u32 s56, 32
s_cselect_b32 s58, s58, s59
s_cselect_b32 s60, 1, 9
s_mul_i32 s59, s60, 9216
s_mul_i32 s60, s60, 2304
s_mul_i32 s58, s58, 1152
s_lshl_b32 s55, s55, 6
s_add_u32 s58, s58, s55
s_cmp_lt_u32 s54, 648
s_cselect_b32 s58, s58, 0x10000000
v_mad_u32_u24 v22, v21, s59, v20
buffer_load_ushort v32, v22, s[64:67], s58 offen offset:0
buffer_load_ushort v33, v22, s[64:67], s58 offen offset:1152
s_add_u32 s58, s58, s60
buffer_load_ushort v34, v22, s[64:67], s58 offen offset:0
buffer_load_ushort v35, v22, s[64:67], s58 offen offset:1152
s_add_u32 s58, s58, s60
buffer_load_ushort v36, v22, s[64:67], s58 offen offset:0
buffer_load_ushort v37, v22, s[64:67], s58 offen offset:1152
s_add_u32 s58, s58, s60
buffer_load_ushort v38, v22, s[64:67], s58 offen offset:0
buffer_load_ushort v39, v22, s[64:67], s58 offen offset:1152
s_add_u32 s54, s54, 576
s_mul_i32 s55, s54, 1821
s_lshr_b32 s55, s55, 16
s_mul_i32 s56, s55, 36
s_sub_u32 s56, s54, s56
s_mul_i32 s58, s56, 18
s_mul_i32 s59, s56, 144
s_sub_u32 s59, s59, 4592
s_cmp_lt_u32 s56, 32
s_cselect_b32 s58, s58, s59
s_cselect_b32 s60, 1, 9
s_mul_i32 s59, s60, 9216
s_mul_i32 s60, s60, 2304
s_mul_i32 s58, s58, 1152
s_lshl_b32 s55, s55, 6
s_add_u32 s58, s58, s55
s_cmp_lt_u32 s54, 648
s_cselect_b32 s58, s58, 0x10000000
v_mad_u32_u24 v23, v21, s59, v20
buffer_load_ushort v40, v23, s[64:67], s58 offen offset:0
buffer_load_ushort v41, v23, s[64:67], s58 offen offset:1152
s_add_u32 s58, s58, s60
buffer_load_ushort v42, v23, s[64:67], s58 offen offset:0
buffer_load_ushort v43, v23, s[64:67], s58 offen offset:1152
s_add_u32 s58, s58, s60
buffer_load_ushort v44, v23, s[64:67], s58 offen offset:0
buffer_load_ushort v45, v23, s[64:67], s58 offen offset:1152
s_add_u32 s58, s58, s60
buffer_load_ushort v46, v23, s[64:67], s58 offen offset:0
buffer_load_ushort v47, v23, s[64:67], s58 offen offset:1152
s_waitcnt vmcnt(32)
s_barrier
s_waitcnt vmcnt(24)
s_barrier
s_waitcnt vmcnt(16)
s_barrier
v_lshlrev_b32 v20, 4, v0
s_lshl_b32 s54, s54, 10
s_sub_u32 s55, s54, 589824
s_waitcnt vmcnt(8)
v_lshl_or_b32 v24, v33, 16, v32
v_lshl_or_b32 v25, v35, 16, v34
v_lshl_or_b32 v26, v37, 16, v36
v_lshl_or_b32 v27, v39, 16, v38
buffer_store_dwordx4 v[24:27], v20, s[68:71], s55 offen
s_waitcnt vmcnt(1)
v_lshl_or_b32 v28, v41, 16, v40
v_lshl_or_b32 v29, v43, 16, v42
v_lshl_or_b32 v30, v45, 16, v44
v_lshl_or_b32 v31, v47, 16, v46
buffer_store_dwordx4 v[28:31], v20, s[68:71], s54 offen
s_endpgm
k1_ld12:
s_cmp_eq_u32 s5, 15
s_cbranch_scc1 k1_t2
v_lshrrev_b32 v10, 3, v0
v_lshrrev_b32 v11, 4, v0
s_and_b32 s61, s6, 1
s_lshl_b32 s61, s61, 2
v_add_u32 v11, s61, v11
v_and_b32 v2, 7, v0
v_xor_b32 v2, v2, v11
v_lshlrev_b32 v2, 4, v2
s_mul_i32 s61, s6, 8
v_add_u32 v10, s61, v10
v_mul_u32_u24 v10, 1152, v10
v_add_u32 v2, v2, v10
s_mul_i32 s54, s4, 147456
s_lshl_b32 s62, s6, 10
s_lshl_b32 s61, s6, 6
s_mul_i32 s55, s7, 192
v_add_u32 v10, s61, v0
v_mul_u32_u24 v11, 5462, v10
v_lshrrev_b32 v11, 16, v11
v_mul_u32_u24 v12, 12, v11
v_sub_u32 v12, v10, v12
v_mul_u32_u24 v11, 1152, v11
v_lshl_add_u32 v3, v12, 4, v11
v_add_u32 v10, s61, v0
v_add_u32 v10, 256, v10
v_mul_u32_u24 v11, 5462, v10
v_lshrrev_b32 v11, 16, v11
v_mul_u32_u24 v12, 12, v11
v_sub_u32 v12, v10, v12
v_mul_u32_u24 v11, 1152, v11
v_lshl_add_u32 v4, v12, 4, v11
v_add_u32 v10, s61, v0
v_add_u32 v10, 512, v10
v_mul_u32_u24 v11, 5462, v10
v_lshrrev_b32 v11, 16, v11
v_mul_u32_u24 v12, 12, v11
v_sub_u32 v12, v10, v12
v_mul_u32_u24 v11, 1152, v11
v_lshl_add_u32 v5, v12, 4, v11
s_waitcnt lgkmcnt(0)
s_mov_b32 s64, s34
s_and_b32 s65, s35, 0xffff
s_mov_b32 s66, 2359296
s_mov_b32 s67, 0x20000
s_mov_b32 s68, s36
s_and_b32 s69, s37, 0xffff
s_mov_b32 s70, 663552
s_mov_b32 s71, 0x20000
s_and_b32 s56, s2, 7
s_lshr_b32 s59, s2, 3
s_add_u32 s56, s56, s59
s_and_b32 s56, s56, 7
s_mul_i32 s59, s56, 128
s_add_u32 s54, s54, s59
s_mul_i32 s59, s56, 73728
s_add_u32 s55, s55, s59
s_mov_b32 s57, 0
s_mov_b32 s58, 0
k1_t1_lp:
s_cmp_lt_u32 s57, 3
s_cbranch_scc1 k1_t1_lnw
s_waitcnt vmcnt(14)
s_barrier
k1_t1_lnw:
s_mov_b32 m0, s62
s_nop 0
buffer_load_dwordx4 v2, s[64:67], s54 offen lds
s_add_u32 m0, s62, 4096
s_add_u32 s60, s54, 36864
buffer_load_dwordx4 v2, s[64:67], s60 offen lds
s_add_u32 m0, s62, 8192
s_add_u32 s60, s54, 73728
buffer_load_dwordx4 v2, s[64:67], s60 offen lds
s_add_u32 m0, s62, 12288
s_add_u32 s60, s54, 110592
buffer_load_dwordx4 v2, s[64:67], s60 offen lds
s_add_u32 m0, s62, 16384
s_nop 0
buffer_load_dwordx4 v3, s[68:71], s55 offen lds
s_add_u32 m0, s62, 20480
s_nop 0
buffer_load_dwordx4 v4, s[68:71], s55 offen lds
s_add_u32 m0, s62, 24576
s_nop 0
buffer_load_dwordx4 v5, s[68:71], s55 offen lds
s_add_u32 s54, s54, 128
s_add_u32 s55, s55, 73728
s_add_u32 s57, s57, 1
s_add_u32 s58, s58, 1
s_cmp_eq_u32 s58, 4
s_cselect_b32 s58, 0, s58
s_mov_b32 s59, 28672
s_cselect_b32 s59, 4294881280, s59
s_add_u32 s62, s62, s59
s_add_u32 s56, s56, 1
s_cmp_lg_u32 s56, 9
s_cbranch_scc1 k1_t1_nw
s_sub_u32 s54, s54, 1152
s_sub_u32 s55, s55, 663552
k1_t1_nw:
s_cmp_lt_u32 s57, 9
s_cbranch_scc1 k1_t1_lp
s_lshl_b32 s56, s7, 4
s_add_u32 s56, s56, s4
s_cmp_ge_u32 s56, 54
s_cselect_b32 s72, s28, s26
s_cselect_b32 s73, s29, s27
s_cselect_b32 s58, 36, 0
s_cselect_b32 s59, 54, 0
s_and_b32 s73, s73, 0xffff
s_mov_b32 s74, 663552
s_mov_b32 s75, 0x20000
s_sub_u32 s59, s56, s59
s_mul_i32 s60, s59, 43
s_lshr_b32 s60, s60, 7
s_mul_i32 s61, s60, 3
s_sub_u32 s59, s59, s61
s_mul_i32 s59, s59, 3
s_add_u32 s59, s59, s6
s_mul_i32 s61, s60, 72
s_add_u32 s58, s58, s61
s_lshl_b32 s61, s59, 2
s_add_u32 s58, s58, s61
s_lshl_b32 s58, s58, 10
s_mul_i32 s60, s60, 36864
s_lshl_b32 s59, s59, 7
s_add_u32 s60, s60, s59
s_cmp_lt_u32 s56, 108
s_cselect_b32 s56, 0, 1
s_cmp_eq_u32 s6, 3
s_cselect_b32 s56, 1, s56
s_cmp_eq_u32 s56, 1
s_cselect_b32 s60, 0x10000000, s60
v_lshrrev_b32 v20, 3, v0
v_lshrrev_b32 v21, 4, v0
v_and_b32 v22, 7, v0
v_xor_b32 v22, v22, v21
v_lshlrev_b32 v22, 4, v22
v_mul_u32_u24 v20, 1152, v20
v_add_u32 v20, v20, v22
v_xor_b32 v21, 64, v20
s_lshl_b32 s61, s6, 12
s_add_u32 s61, s61, 116736
s_add_u32 m0, s61, 0
s_add_u32 s59, s60, 0
buffer_load_dwordx4 v20, s[72:75], s59 offen lds
s_add_u32 m0, s61, 1024
s_add_u32 s59, s60, 9216
buffer_load_dwordx4 v21, s[72:75], s59 offen lds
s_add_u32 m0, s61, 2048
s_add_u32 s59, s60, 18432
buffer_load_dwordx4 v20, s[72:75], s59 offen lds
s_add_u32 m0, s61, 3072
s_add_u32 s59, s60, 27648
buffer_load_dwordx4 v21, s[72:75], s59 offen lds
s_waitcnt vmcnt(18)
s_barrier
s_waitcnt vmcnt(11)
s_barrier
s_waitcnt vmcnt(4)
s_barrier
s_cmp_eq_u32 s56, 1
s_cbranch_scc1 k1_t1_cfx
v_and_b32 v22, 31, v0
v_lshrrev_b32 v23, 1, v22
v_and_b32 v23, 7, v23
v_lshrrev_b32 v24, 5, v0
v_xor_b32 v23, v23, v24
v_lshlrev_b32 v23, 4, v23
v_lshl_add_u32 v24, v22, 7, v23
v_add_u32 v24, s61, v24
v_xor_b32 v25, 32, v24
v_xor_b32 v26, 64, v24
v_xor_b32 v27, 96, v24
s_add_u32 s72, s48, 10063872
s_addc_u32 s73, s49, 0
s_and_b32 s73, s73, 0xffff
s_mov_b32 s74, 1327104
s_mov_b32 s75, 0x20000
v_lshlrev_b32 v20, 4, v0
s_waitcnt vmcnt(0)
ds_read_b128 v[32:35], v24 offset:0
ds_read_b128 v[36:39], v25 offset:0
ds_read_b128 v[40:43], v26 offset:0
ds_read_b128 v[44:47], v27 offset:0
s_waitcnt lgkmcnt(3)
buffer_store_dwordx4 v[32:35], v20, s[72:75], s58 offen offset:0
s_waitcnt lgkmcnt(2)
buffer_store_dwordx4 v[36:39], v20, s[72:75], s58 offen offset:1024
s_waitcnt lgkmcnt(1)
buffer_store_dwordx4 v[40:43], v20, s[72:75], s58 offen offset:2048
s_waitcnt lgkmcnt(0)
buffer_store_dwordx4 v[44:47], v20, s[72:75], s58 offen offset:3072
s_branch k1_t1_cfy
k1_t1_cfx:
s_lshl_b32 s59, s7, 4
s_add_u32 s59, s59, s4
s_cmp_ge_u32 s59, 64
s_cbranch_scc1 k1_t1_cfy
s_add_u32 s72, s48, 16109568
s_addc_u32 s73, s49, 0
s_and_b32 s73, s73, 0xffff
s_mov_b32 s74, 16384
s_mov_b32 s75, 0x20000
s_lshl_b32 s59, s59, 8
v_lshlrev_b32 v20, 2, v0
v_mov_b32 v21, 0
buffer_store_dword v21, v20, s[72:75], s59 offen
k1_t1_cfy:
s_endpgm
k1_t2:
v_lshrrev_b32 v10, 3, v0
v_lshrrev_b32 v11, 4, v0
s_and_b32 s61, s6, 1
s_lshl_b32 s61, s61, 2
v_add_u32 v11, s61, v11
v_and_b32 v2, 7, v0
v_xor_b32 v2, v2, v11
v_lshlrev_b32 v2, 4, v2
s_mul_i32 s61, s6, 8
v_add_u32 v10, s61, v10
v_mul_u32_u24 v10, 1152, v10
v_add_u32 v2, v2, v10
s_mul_i32 s54, s4, 147456
s_lshl_b32 s62, s6, 10
s_lshl_b32 s63, s6, 8
s_lshl_b32 s61, s6, 6
v_add_u32 v10, s61, v0
v_mul_u32_u24 v11, 6554, v10
v_lshrrev_b32 v11, 16, v11
v_mul_u32_u24 v12, 10, v11
v_sub_u32 v12, v10, v12
v_min_u32 v12, 8, v12
v_mul_u32_u24 v11, 36, v11
v_lshl_add_u32 v3, v12, 2, v11
v_add_u32 v10, s61, v0
v_add_u32 v10, 256, v10
v_mul_u32_u24 v11, 6554, v10
v_lshrrev_b32 v11, 16, v11
v_mul_u32_u24 v12, 10, v11
v_sub_u32 v12, v10, v12
v_min_u32 v12, 8, v12
v_mul_u32_u24 v11, 36, v11
v_lshl_add_u32 v4, v12, 2, v11
v_add_u32 v10, s61, v0
v_add_u32 v10, 512, v10
v_mul_u32_u24 v11, 6554, v10
v_lshrrev_b32 v11, 16, v11
v_mul_u32_u24 v12, 10, v11
v_sub_u32 v12, v10, v12
v_min_u32 v12, 8, v12
v_mul_u32_u24 v11, 36, v11
v_lshl_add_u32 v5, v12, 2, v11
v_add_u32 v10, s61, v0
v_add_u32 v10, 768, v10
v_mul_u32_u24 v11, 6554, v10
v_lshrrev_b32 v11, 16, v11
v_mul_u32_u24 v12, 10, v11
v_sub_u32 v12, v10, v12
v_min_u32 v12, 8, v12
v_mul_u32_u24 v11, 36, v11
v_lshl_add_u32 v6, v12, 2, v11
v_add_u32 v10, s61, v0
v_add_u32 v10, 1024, v10
v_mul_u32_u24 v11, 6554, v10
v_lshrrev_b32 v11, 16, v11
v_mul_u32_u24 v12, 10, v11
v_sub_u32 v12, v10, v12
v_min_u32 v12, 8, v12
v_mul_u32_u24 v11, 36, v11
v_lshl_add_u32 v7, v12, 2, v11
s_waitcnt lgkmcnt(0)
s_mov_b32 s64, s34
s_and_b32 s65, s35, 0xffff
s_mov_b32 s66, 2359296
s_mov_b32 s67, 0x20000
s_mov_b32 s68, s38
s_and_b32 s69, s39, 0xffff
s_mov_b32 s70, 20736
s_mov_b32 s71, 0x20000
s_mov_b32 s72, s40
s_and_b32 s73, s41, 0xffff
s_mov_b32 s74, 20736
s_mov_b32 s75, 0x20000
s_mov_b32 s60, 0
k1_t2_w:
s_add_u32 m0, s63, 65536
s_nop 0
buffer_load_dword v3, s[68:71], s60 offen lds
s_add_u32 m0, s63, 91136
s_nop 0
buffer_load_dword v3, s[72:75], s60 offen lds
s_add_u32 m0, s63, 66560
s_nop 0
buffer_load_dword v4, s[68:71], s60 offen lds
s_add_u32 m0, s63, 92160
s_nop 0
buffer_load_dword v4, s[72:75], s60 offen lds
s_add_u32 m0, s63, 67584
s_nop 0
buffer_load_dword v5, s[68:71], s60 offen lds
s_add_u32 m0, s63, 93184
s_nop 0
buffer_load_dword v5, s[72:75], s60 offen lds
s_add_u32 m0, s63, 68608
s_nop 0
buffer_load_dword v6, s[68:71], s60 offen lds
s_add_u32 m0, s63, 94208
s_nop 0
buffer_load_dword v6, s[72:75], s60 offen lds
s_add_u32 m0, s63, 69632
s_nop 0
buffer_load_dword v7, s[68:71], s60 offen lds
s_add_u32 m0, s63, 95232
s_nop 0
buffer_load_dword v7, s[72:75], s60 offen lds
s_add_u32 s63, s63, 5120
s_add_u32 s60, s60, 4608
s_cmp_lt_u32 s60, 23040
s_cbranch_scc1 k1_t2_w
s_mov_b32 s57, 0
s_mov_b32 s58, 0
k1_t2_lp:
s_cmp_lt_u32 s57, 3
s_cbranch_scc1 k1_t2_lnw
s_waitcnt vmcnt(8)
s_barrier
k1_t2_lnw:
s_mov_b32 m0, s62
s_nop 0
buffer_load_dwordx4 v2, s[64:67], s54 offen lds
s_add_u32 m0, s62, 4096
s_add_u32 s60, s54, 36864
buffer_load_dwordx4 v2, s[64:67], s60 offen lds
s_add_u32 m0, s62, 8192
s_add_u32 s60, s54, 73728
buffer_load_dwordx4 v2, s[64:67], s60 offen lds
s_add_u32 m0, s62, 12288
s_add_u32 s60, s54, 110592
buffer_load_dwordx4 v2, s[64:67], s60 offen lds
s_add_u32 s54, s54, 128
s_add_u32 s57, s57, 1
s_add_u32 s58, s58, 1
s_cmp_eq_u32 s58, 4
s_cselect_b32 s58, 0, s58
s_mov_b32 s59, 16384
s_cselect_b32 s59, 4294918144, s59
s_add_u32 s62, s62, s59
s_cmp_lt_u32 s57, 9
s_cbranch_scc1 k1_t2_lp
s_lshl_b32 s56, s7, 4
s_add_u32 s56, s56, s4
s_cmp_ge_u32 s56, 54
s_cselect_b32 s72, s28, s26
s_cselect_b32 s73, s29, s27
s_cselect_b32 s58, 36, 0
s_cselect_b32 s59, 54, 0
s_and_b32 s73, s73, 0xffff
s_mov_b32 s74, 663552
s_mov_b32 s75, 0x20000
s_sub_u32 s59, s56, s59
s_mul_i32 s60, s59, 43
s_lshr_b32 s60, s60, 7
s_mul_i32 s61, s60, 3
s_sub_u32 s59, s59, s61
s_mul_i32 s59, s59, 3
s_add_u32 s59, s59, s6
s_mul_i32 s61, s60, 72
s_add_u32 s58, s58, s61
s_lshl_b32 s61, s59, 2
s_add_u32 s58, s58, s61
s_lshl_b32 s58, s58, 10
s_mul_i32 s60, s60, 36864
s_lshl_b32 s59, s59, 7
s_add_u32 s60, s60, s59
s_cmp_lt_u32 s56, 108
s_cselect_b32 s56, 0, 1
s_cmp_eq_u32 s6, 3
s_cselect_b32 s56, 1, s56
s_cmp_eq_u32 s56, 1
s_cselect_b32 s60, 0x10000000, s60
v_lshrrev_b32 v20, 3, v0
v_lshrrev_b32 v21, 4, v0
v_and_b32 v22, 7, v0
v_xor_b32 v22, v22, v21
v_lshlrev_b32 v22, 4, v22
v_mul_u32_u24 v20, 1152, v20
v_add_u32 v20, v20, v22
v_xor_b32 v21, 64, v20
s_lshl_b32 s61, s6, 12
s_add_u32 s61, s61, 116736
s_add_u32 m0, s61, 0
s_add_u32 s59, s60, 0
buffer_load_dwordx4 v20, s[72:75], s59 offen lds
s_add_u32 m0, s61, 1024
s_add_u32 s59, s60, 9216
buffer_load_dwordx4 v21, s[72:75], s59 offen lds
s_add_u32 m0, s61, 2048
s_add_u32 s59, s60, 18432
buffer_load_dwordx4 v20, s[72:75], s59 offen lds
s_add_u32 m0, s61, 3072
s_add_u32 s59, s60, 27648
buffer_load_dwordx4 v21, s[72:75], s59 offen lds
s_waitcnt vmcnt(12)
s_barrier
s_waitcnt vmcnt(8)
s_barrier
s_waitcnt vmcnt(4)
s_barrier
s_cmp_eq_u32 s56, 1
s_cbranch_scc1 k1_t2_cfx
v_and_b32 v22, 31, v0
v_lshrrev_b32 v23, 1, v22
v_and_b32 v23, 7, v23
v_lshrrev_b32 v24, 5, v0
v_xor_b32 v23, v23, v24
v_lshlrev_b32 v23, 4, v23
v_lshl_add_u32 v24, v22, 7, v23
v_add_u32 v24, s61, v24
v_xor_b32 v25, 32, v24
v_xor_b32 v26, 64, v24
v_xor_b32 v27, 96, v24
s_add_u32 s72, s48, 10063872
s_addc_u32 s73, s49, 0
s_and_b32 s73, s73, 0xffff
s_mov_b32 s74, 1327104
s_mov_b32 s75, 0x20000
v_lshlrev_b32 v20, 4, v0
s_waitcnt vmcnt(0)
ds_read_b128 v[32:35], v24 offset:0
ds_read_b128 v[36:39], v25 offset:0
ds_read_b128 v[40:43], v26 offset:0
ds_read_b128 v[44:47], v27 offset:0
s_waitcnt lgkmcnt(3)
buffer_store_dwordx4 v[32:35], v20, s[72:75], s58 offen offset:0
s_waitcnt lgkmcnt(2)
buffer_store_dwordx4 v[36:39], v20, s[72:75], s58 offen offset:1024
s_waitcnt lgkmcnt(1)
buffer_store_dwordx4 v[40:43], v20, s[72:75], s58 offen offset:2048
s_waitcnt lgkmcnt(0)
buffer_store_dwordx4 v[44:47], v20, s[72:75], s58 offen offset:3072
s_branch k1_t2_cfy
k1_t2_cfx:
s_lshl_b32 s59, s7, 4
s_add_u32 s59, s59, s4
s_cmp_ge_u32 s59, 64
s_cbranch_scc1 k1_t2_cfy
s_add_u32 s72, s48, 16109568
s_addc_u32 s73, s49, 0
s_and_b32 s73, s73, 0xffff
s_mov_b32 s74, 16384
s_mov_b32 s75, 0x20000
s_lshl_b32 s59, s59, 8
v_lshlrev_b32 v20, 2, v0
v_mov_b32 v21, 0
buffer_store_dword v21, v20, s[72:75], s59 offen
k1_t2_cfy:
s_endpgm
k1_comp:
s_cmp_lt_u32 s5, 9
s_cbranch_scc1 k1_t3_comp
s_cmp_eq_u32 s5, 15
s_cbranch_scc1 k1_t2_comp
v_and_b32 v12, 31, v0
v_lshrrev_b32 v13, 1, v12
v_and_b32 v13, 7, v13
v_lshrrev_b32 v2, 5, v0
v_xor_b32 v13, v13, v2
v_lshlrev_b32 v13, 4, v13
v_lshl_add_u32 v2, v12, 7, v13
s_lshl_b32 s61, s6, 12
v_add_u32 v2, s61, v2
v_xor_b32 v3, 32, v2
v_xor_b32 v4, 64, v2
v_xor_b32 v5, 96, v2
v_lshrrev_b32 v12, 5, v0
v_lshlrev_b32 v12, 3, v12
v_bfe_u32 v10, v0, 2, 2
v_add_u32 v12, v12, v10
v_mul_u32_u24 v10, 192, v12
v_bfe_u32 v13, v0, 4, 1
v_lshlrev_b32 v13, 5, v13
v_and_b32 v14, 3, v0
v_lshl_add_u32 v13, v14, 3, v13
v_add_u32 v10, v10, v13
v_mov_b32 v16, 0
v_mov_b32 v17, 0
v_mov_b32 v18, 0
v_mov_b32 v19, 0
v_mov_b32 v20, 0
v_mov_b32 v21, 0
v_mov_b32 v22, 0
v_mov_b32 v23, 0
v_mov_b32 v24, 0
v_mov_b32 v25, 0
v_mov_b32 v26, 0
v_mov_b32 v27, 0
v_mov_b32 v28, 0
v_mov_b32 v29, 0
v_mov_b32 v30, 0
v_mov_b32 v31, 0
v_mov_b32 v32, 0
v_mov_b32 v33, 0
v_mov_b32 v34, 0
v_mov_b32 v35, 0
v_mov_b32 v36, 0
v_mov_b32 v37, 0
v_mov_b32 v38, 0
v_mov_b32 v39, 0
v_mov_b32 v40, 0
v_mov_b32 v41, 0
v_mov_b32 v42, 0
v_mov_b32 v43, 0
v_mov_b32 v44, 0
v_mov_b32 v45, 0
v_mov_b32 v46, 0
v_mov_b32 v47, 0
v_mov_b32 v48, 0
v_mov_b32 v49, 0
v_mov_b32 v50, 0
v_mov_b32 v51, 0
v_mov_b32 v52, 0
v_mov_b32 v53, 0
v_mov_b32 v54, 0
v_mov_b32 v55, 0
v_mov_b32 v56, 0
v_mov_b32 v57, 0
v_mov_b32 v58, 0
v_mov_b32 v59, 0
v_mov_b32 v60, 0
v_mov_b32 v61, 0
v_mov_b32 v62, 0
v_mov_b32 v63, 0
s_waitcnt lgkmcnt(0)
s_mov_b32 s64, s48
s_and_b32 s65, s49, 0xffff
s_mov_b32 s66, 2359296
s_mov_b32 s67, 0x20000
v_and_b32 v12, 31, v0
s_lshl_b32 s61, s4, 7
s_lshl_b32 s62, s6, 5
s_add_u32 s61, s61, s62
v_add_u32 v12, s61, v12
v_mul_u32_u24 v12, 1152, v12
v_lshrrev_b32 v13, 5, v0
v_lshl_add_u32 v12, v13, 3, v12
s_mul_i32 s61, s7, 192
v_add_u32 v12, s61, v12
s_mov_b32 s62, 1051597459
s_mov_b32 s57, 1
s_mov_b32 s58, 0
s_waitcnt lgkmcnt(0)
s_barrier
ds_read_b128 v[64:67], v2 offset:0
ds_read_b64_tr_b16 v[68:69], v10 offset:16384
ds_read_b64_tr_b16 v[70:71], v10 offset:17152
ds_read_b64_tr_b16 v[72:73], v10 offset:16448
ds_read_b64_tr_b16 v[74:75], v10 offset:17216
ds_read_b64_tr_b16 v[76:77], v10 offset:16512
ds_read_b64_tr_b16 v[78:79], v10 offset:17280
k1_t1_cl:
ds_read_b128 v[80:83], v3 offset:0
ds_read_b64_tr_b16 v[84:85], v10 offset:19456
ds_read_b64_tr_b16 v[86:87], v10 offset:20224
ds_read_b64_tr_b16 v[88:89], v10 offset:19520
ds_read_b64_tr_b16 v[90:91], v10 offset:20288
ds_read_b64_tr_b16 v[92:93], v10 offset:19584
ds_read_b64_tr_b16 v[94:95], v10 offset:20352
s_waitcnt lgkmcnt(7)
v_mfma_f32_32x32x16_bf16 v[16:31], v[68:71], v[64:67], v[16:31]
v_mfma_f32_32x32x16_bf16 v[32:47], v[72:75], v[64:67], v[32:47]
v_mfma_f32_32x32x16_bf16 v[48:63], v[76:79], v[64:67], v[48:63]
ds_read_b128 v[64:67], v4 offset:0
ds_read_b64_tr_b16 v[68:69], v10 offset:22528
ds_read_b64_tr_b16 v[70:71], v10 offset:23296
ds_read_b64_tr_b16 v[72:73], v10 offset:22592
ds_read_b64_tr_b16 v[74:75], v10 offset:23360
ds_read_b64_tr_b16 v[76:77], v10 offset:22656
ds_read_b64_tr_b16 v[78:79], v10 offset:23424
s_waitcnt lgkmcnt(7)
v_mfma_f32_32x32x16_bf16 v[16:31], v[84:87], v[80:83], v[16:31]
v_mfma_f32_32x32x16_bf16 v[32:47], v[88:91], v[80:83], v[32:47]
v_mfma_f32_32x32x16_bf16 v[48:63], v[92:95], v[80:83], v[48:63]
ds_read_b128 v[80:83], v5 offset:0
ds_read_b64_tr_b16 v[84:85], v10 offset:25600
ds_read_b64_tr_b16 v[86:87], v10 offset:26368
ds_read_b64_tr_b16 v[88:89], v10 offset:25664
ds_read_b64_tr_b16 v[90:91], v10 offset:26432
ds_read_b64_tr_b16 v[92:93], v10 offset:25728
ds_read_b64_tr_b16 v[94:95], v10 offset:26496
s_add_u32 s58, s58, 1
s_cmp_eq_u32 s58, 4
s_cselect_b32 s58, 0, s58
s_mov_b32 s59, 28672
s_cselect_b32 s59, 4294881280, s59
v_add_u32 v2, s59, v2
v_add_u32 v3, s59, v3
v_add_u32 v4, s59, v4
v_add_u32 v5, s59, v5
v_add_u32 v10, s59, v10
s_waitcnt lgkmcnt(7)
v_mfma_f32_32x32x16_bf16 v[16:31], v[68:71], v[64:67], v[16:31]
v_mfma_f32_32x32x16_bf16 v[32:47], v[72:75], v[64:67], v[32:47]
v_mfma_f32_32x32x16_bf16 v[48:63], v[76:79], v[64:67], v[48:63]
s_waitcnt lgkmcnt(0)
s_cmp_eq_u32 s57, 9
s_cbranch_scc1 k1_t1_cx
s_add_u32 s57, s57, 1
s_barrier
ds_read_b128 v[64:67], v2 offset:0
ds_read_b64_tr_b16 v[68:69], v10 offset:16384
ds_read_b64_tr_b16 v[70:71], v10 offset:17152
ds_read_b64_tr_b16 v[72:73], v10 offset:16448
ds_read_b64_tr_b16 v[74:75], v10 offset:17216
ds_read_b64_tr_b16 v[76:77], v10 offset:16512
ds_read_b64_tr_b16 v[78:79], v10 offset:17280
v_mfma_f32_32x32x16_bf16 v[16:31], v[84:87], v[80:83], v[16:31]
v_mfma_f32_32x32x16_bf16 v[32:47], v[88:91], v[80:83], v[32:47]
v_mfma_f32_32x32x16_bf16 v[48:63], v[92:95], v[80:83], v[48:63]
s_branch k1_t1_cl
k1_t1_cx:
v_mfma_f32_32x32x16_bf16 v[16:31], v[84:87], v[80:83], v[16:31]
v_mfma_f32_32x32x16_bf16 v[32:47], v[88:91], v[80:83], v[32:47]
v_mfma_f32_32x32x16_bf16 v[48:63], v[92:95], v[80:83], v[48:63]
s_nop 9
v_mul_f32 v16, s62, v16
v_mul_f32 v17, s62, v17
v_mul_f32 v18, s62, v18
v_mul_f32 v19, s62, v19
v_cvt_pk_bf16_f32 v16, v16, v17
v_cvt_pk_bf16_f32 v17, v18, v19
buffer_store_dwordx2 v[16:17], v12, s[64:67], 0 offen offset:0
v_mul_f32 v20, s62, v20
v_mul_f32 v21, s62, v21
v_mul_f32 v22, s62, v22
v_mul_f32 v23, s62, v23
v_cvt_pk_bf16_f32 v20, v20, v21
v_cvt_pk_bf16_f32 v21, v22, v23
buffer_store_dwordx2 v[20:21], v12, s[64:67], 0 offen offset:16
v_mul_f32 v24, s62, v24
v_mul_f32 v25, s62, v25
v_mul_f32 v26, s62, v26
v_mul_f32 v27, s62, v27
v_cvt_pk_bf16_f32 v24, v24, v25
v_cvt_pk_bf16_f32 v25, v26, v27
buffer_store_dwordx2 v[24:25], v12, s[64:67], 0 offen offset:32
v_mul_f32 v28, s62, v28
v_mul_f32 v29, s62, v29
v_mul_f32 v30, s62, v30
v_mul_f32 v31, s62, v31
v_cvt_pk_bf16_f32 v28, v28, v29
v_cvt_pk_bf16_f32 v29, v30, v31
buffer_store_dwordx2 v[28:29], v12, s[64:67], 0 offen offset:48
v_mul_f32 v32, s62, v32
v_mul_f32 v33, s62, v33
v_mul_f32 v34, s62, v34
v_mul_f32 v35, s62, v35
v_cvt_pk_bf16_f32 v32, v32, v33
v_cvt_pk_bf16_f32 v33, v34, v35
buffer_store_dwordx2 v[32:33], v12, s[64:67], 0 offen offset:64
v_mul_f32 v36, s62, v36
v_mul_f32 v37, s62, v37
v_mul_f32 v38, s62, v38
v_mul_f32 v39, s62, v39
v_cvt_pk_bf16_f32 v36, v36, v37
v_cvt_pk_bf16_f32 v37, v38, v39
buffer_store_dwordx2 v[36:37], v12, s[64:67], 0 offen offset:80
v_mul_f32 v40, s62, v40
v_mul_f32 v41, s62, v41
v_mul_f32 v42, s62, v42
v_mul_f32 v43, s62, v43
v_cvt_pk_bf16_f32 v40, v40, v41
v_cvt_pk_bf16_f32 v41, v42, v43
buffer_store_dwordx2 v[40:41], v12, s[64:67], 0 offen offset:96
v_mul_f32 v44, s62, v44
v_mul_f32 v45, s62, v45
v_mul_f32 v46, s62, v46
v_mul_f32 v47, s62, v47
v_cvt_pk_bf16_f32 v44, v44, v45
v_cvt_pk_bf16_f32 v45, v46, v47
buffer_store_dwordx2 v[44:45], v12, s[64:67], 0 offen offset:112
v_mul_f32 v48, s62, v48
v_mul_f32 v49, s62, v49
v_mul_f32 v50, s62, v50
v_mul_f32 v51, s62, v51
v_cvt_pk_bf16_f32 v48, v48, v49
v_cvt_pk_bf16_f32 v49, v50, v51
buffer_store_dwordx2 v[48:49], v12, s[64:67], 0 offen offset:128
v_mul_f32 v52, s62, v52
v_mul_f32 v53, s62, v53
v_mul_f32 v54, s62, v54
v_mul_f32 v55, s62, v55
v_cvt_pk_bf16_f32 v52, v52, v53
v_cvt_pk_bf16_f32 v53, v54, v55
buffer_store_dwordx2 v[52:53], v12, s[64:67], 0 offen offset:144
v_mul_f32 v56, s62, v56
v_mul_f32 v57, s62, v57
v_mul_f32 v58, s62, v58
v_mul_f32 v59, s62, v59
v_cvt_pk_bf16_f32 v56, v56, v57
v_cvt_pk_bf16_f32 v57, v58, v59
buffer_store_dwordx2 v[56:57], v12, s[64:67], 0 offen offset:160
v_mul_f32 v60, s62, v60
v_mul_f32 v61, s62, v61
v_mul_f32 v62, s62, v62
v_mul_f32 v63, s62, v63
v_cvt_pk_bf16_f32 v60, v60, v61
v_cvt_pk_bf16_f32 v61, v62, v63
buffer_store_dwordx2 v[60:61], v12, s[64:67], 0 offen offset:176
s_endpgm
k1_t2_comp:
s_lshl_b32 s61, s6, 12
s_add_u32 s61, s61, 8192
v_lshlrev_b32 v160, 4, v0
v_add_u32 v160, s61, v160
global_load_dwordx4 v[164:167], v160, s[50:51] offset:0
global_load_dwordx4 v[164:167], v160, s[50:51] offset:1024
global_load_dwordx4 v[164:167], v160, s[50:51] offset:2048
global_load_dwordx4 v[164:167], v160, s[50:51] offset:3072
v_and_b32 v12, 31, v0
v_lshrrev_b32 v13, 1, v12
v_and_b32 v13, 7, v13
v_lshrrev_b32 v2, 5, v0
v_xor_b32 v13, v13, v2
v_lshlrev_b32 v13, 4, v13
v_lshl_add_u32 v2, v12, 7, v13
s_lshl_b32 s61, s6, 12
v_add_u32 v2, s61, v2
v_xor_b32 v3, 32, v2
v_xor_b32 v4, 64, v2
v_xor_b32 v5, 96, v2
v_lshrrev_b32 v12, 5, v0
v_lshlrev_b32 v12, 3, v12
v_bfe_u32 v10, v0, 2, 2
v_add_u32 v12, v12, v10
v_mul_u32_u24 v10, 40, v12
v_and_b32 v13, 1, v0
v_lshlrev_b32 v13, 1, v13
v_bfe_u32 v14, v0, 1, 1
v_or_b32 v13, v13, v14
v_bfe_u32 v14, v0, 4, 1
v_cmp_eq_u32 vcc, 1, v14
v_mov_b32 v14, 4
s_nop 0
v_cndmask_b32 v13, v13, v14, vcc
v_lshlrev_b32 v13, 3, v13
v_add_u32 v10, v10, v13
v_add_u32 v10, 65536, v10
v_mov_b32 v16, 0
v_mov_b32 v17, 0
v_mov_b32 v18, 0
v_mov_b32 v19, 0
v_mov_b32 v20, 0
v_mov_b32 v21, 0
v_mov_b32 v22, 0
v_mov_b32 v23, 0
v_mov_b32 v24, 0
v_mov_b32 v25, 0
v_mov_b32 v26, 0
v_mov_b32 v27, 0
v_mov_b32 v28, 0
v_mov_b32 v29, 0
v_mov_b32 v30, 0
v_mov_b32 v31, 0
v_mov_b32 v32, 0
v_mov_b32 v33, 0
v_mov_b32 v34, 0
v_mov_b32 v35, 0
v_mov_b32 v36, 0
v_mov_b32 v37, 0
v_mov_b32 v38, 0
v_mov_b32 v39, 0
v_mov_b32 v40, 0
v_mov_b32 v41, 0
v_mov_b32 v42, 0
v_mov_b32 v43, 0
v_mov_b32 v44, 0
v_mov_b32 v45, 0
v_mov_b32 v46, 0
v_mov_b32 v47, 0
s_mov_b32 s57, 1
s_mov_b32 s58, 0
s_waitcnt lgkmcnt(0)
s_barrier
ds_read_b128 v[64:67], v2 offset:0
ds_read_b64_tr_b16 v[68:69], v10 offset:0
ds_read_b64_tr_b16 v[70:71], v10 offset:160
ds_read_b64_tr_b16 v[72:73], v10 offset:25600
ds_read_b64_tr_b16 v[74:75], v10 offset:25760
k1_t2_cl:
ds_read_b128 v[80:83], v3 offset:0
ds_read_b64_tr_b16 v[84:85], v10 offset:640
ds_read_b64_tr_b16 v[86:87], v10 offset:800
ds_read_b64_tr_b16 v[88:89], v10 offset:26240
ds_read_b64_tr_b16 v[90:91], v10 offset:26400
s_waitcnt lgkmcnt(5)
v_mfma_f32_32x32x16_bf16 v[16:31], v[68:71], v[64:67], v[16:31]
v_mfma_f32_32x32x16_bf16 v[32:47], v[64:67], v[72:75], v[32:47]
ds_read_b128 v[64:67], v4 offset:0
ds_read_b64_tr_b16 v[68:69], v10 offset:1280
ds_read_b64_tr_b16 v[70:71], v10 offset:1440
ds_read_b64_tr_b16 v[72:73], v10 offset:26880
ds_read_b64_tr_b16 v[74:75], v10 offset:27040
s_waitcnt lgkmcnt(5)
v_mfma_f32_32x32x16_bf16 v[16:31], v[84:87], v[80:83], v[16:31]
v_mfma_f32_32x32x16_bf16 v[32:47], v[80:83], v[88:91], v[32:47]
ds_read_b128 v[80:83], v5 offset:0
ds_read_b64_tr_b16 v[84:85], v10 offset:1920
ds_read_b64_tr_b16 v[86:87], v10 offset:2080
ds_read_b64_tr_b16 v[88:89], v10 offset:27520
ds_read_b64_tr_b16 v[90:91], v10 offset:27680
s_add_u32 s58, s58, 1
s_cmp_eq_u32 s58, 4
s_cselect_b32 s58, 0, s58
s_mov_b32 s59, 16384
s_cselect_b32 s59, 4294918144, s59
v_add_u32 v2, s59, v2
v_add_u32 v3, s59, v3
v_add_u32 v4, s59, v4
v_add_u32 v5, s59, v5
v_add_u32 v10, 2560, v10
s_waitcnt lgkmcnt(5)
v_mfma_f32_32x32x16_bf16 v[16:31], v[68:71], v[64:67], v[16:31]
v_mfma_f32_32x32x16_bf16 v[32:47], v[64:67], v[72:75], v[32:47]
s_waitcnt lgkmcnt(0)
s_cmp_eq_u32 s57, 9
s_cbranch_scc1 k1_t2_cx
s_add_u32 s57, s57, 1
s_barrier
ds_read_b128 v[64:67], v2 offset:0
ds_read_b64_tr_b16 v[68:69], v10 offset:0
ds_read_b64_tr_b16 v[70:71], v10 offset:160
ds_read_b64_tr_b16 v[72:73], v10 offset:25600
ds_read_b64_tr_b16 v[74:75], v10 offset:25760
v_mfma_f32_32x32x16_bf16 v[16:31], v[84:87], v[80:83], v[16:31]
v_mfma_f32_32x32x16_bf16 v[32:47], v[80:83], v[88:91], v[32:47]
s_branch k1_t2_cl
k1_t2_cx:
v_mfma_f32_32x32x16_bf16 v[16:31], v[84:87], v[80:83], v[16:31]
v_mfma_f32_32x32x16_bf16 v[32:47], v[80:83], v[88:91], v[32:47]
s_add_u32 s64, s48, 4718592
s_addc_u32 s65, s49, 0
s_and_b32 s65, s65, 0xffff
s_mov_b32 s66, 212992
s_mov_b32 s67, 0x20000
s_lshl_b32 s7, s4, 2
s_add_u32 s7, s7, s6
v_lshlrev_b32 v12, 4, v0
s_nop 2
v_cvt_pk_bf16_f32 v48, v16, v17
v_cvt_pk_bf16_f32 v49, v18, v19
v_cvt_pk_bf16_f32 v50, v20, v21
v_cvt_pk_bf16_f32 v51, v22, v23
v_cvt_pk_bf16_f32 v52, v24, v25
s_lshl_b32 s61, s7, 10
buffer_store_dwordx4 v[48:51], v12, s[64:67], s61 offen
s_lshr_b32 s61, s7, 2
s_lshl_b32 s61, s61, 10
s_and_b32 s62, s7, 1
s_lshl_b32 s62, s62, 9
s_add_u32 s61, s61, s62
s_bfe_u32 s62, s7, 0x10001
s_lshl_b32 s62, s62, 3
s_add_u32 s61, s61, s62
s_add_u32 s61, s61, 65536
v_lshrrev_b32 v13, 5, v0
v_lshlrev_b32 v13, 28, v13
v_add_u32 v13, v13, v12
v_mov_b32 v53, 0
buffer_store_dwordx2 v[52:53], v13, s[64:67], s61 offen
v_cvt_pk_bf16_f32 v56, v32, v33
v_cvt_pk_bf16_f32 v57, v34, v35
v_cvt_pk_bf16_f32 v58, v36, v37
v_cvt_pk_bf16_f32 v59, v38, v39
v_cvt_pk_bf16_f32 v60, v40, v41
v_cvt_pk_bf16_f32 v61, v42, v43
v_cvt_pk_bf16_f32 v62, v44, v45
v_cvt_pk_bf16_f32 v63, v46, v47
v_and_b32 v14, 31, v0
v_cmp_eq_u32 vcc, 20, v14
v_mov_b32 v15, 0x3f803f80
s_nop 0
v_cndmask_b32 v56, v56, v15, vcc
v_cndmask_b32 v57, v57, v15, vcc
v_cndmask_b32 v58, v58, v15, vcc
v_cndmask_b32 v59, v59, v15, vcc
v_cndmask_b32 v60, v60, v15, vcc
v_cndmask_b32 v61, v61, v15, vcc
v_cndmask_b32 v62, v62, v15, vcc
v_cndmask_b32 v63, v63, v15, vcc
s_lshl_b32 s61, s7, 11
s_add_u32 s61, s61, 81920
buffer_store_dwordx4 v[56:59], v12, s[64:67], s61 offen
buffer_store_dwordx4 v[60:63], v12, s[64:67], s61 offen offset:1024
s_endpgm
k1_t3_comp:
s_and_b32 s7, s6, 1
s_lshr_b32 s8, s6, 1
s_lshl_b32 s61, s5, 6
s_lshl_b32 s62, s8, 5
s_add_u32 s61, s61, s62
v_and_b32 v1, 31, v0
v_add_u32 v1, s61, v1
v_lshlrev_b32 v20, 1, v1
s_waitcnt lgkmcnt(0)
global_load_ushort v21, v20, s[18:19]
global_load_ushort v22, v20, s[20:21]
global_load_ushort v23, v20, s[30:31]
v_and_b32 v18, 31, v0
v_lshrrev_b32 v19, 1, v18
v_and_b32 v19, 7, v19
v_lshrrev_b32 v2, 5, v0
v_xor_b32 v19, v19, v2
v_lshlrev_b32 v19, 4, v19
v_lshl_add_u32 v2, v18, 7, v19
v_mov_b32 v6, v2
s_lshl_b32 s61, s7, 13
v_add_u32 v2, s61, v2
s_lshl_b32 s61, s8, 12
v_add_u32 v6, s61, v6
v_xor_b32 v3, 32, v2
v_xor_b32 v4, 64, v2
v_xor_b32 v5, 96, v2
v_xor_b32 v7, 32, v6
v_xor_b32 v8, 64, v6
v_xor_b32 v9, 96, v6
v_mov_b32 v64, 0
v_mov_b32 v65, 0
v_mov_b32 v66, 0
v_mov_b32 v67, 0
v_mov_b32 v68, 0
v_mov_b32 v69, 0
v_mov_b32 v70, 0
v_mov_b32 v71, 0
v_mov_b32 v72, 0
v_mov_b32 v73, 0
v_mov_b32 v74, 0
v_mov_b32 v75, 0
v_mov_b32 v76, 0
v_mov_b32 v77, 0
v_mov_b32 v78, 0
v_mov_b32 v79, 0
v_mov_b32 v80, 0
v_mov_b32 v81, 0
v_mov_b32 v82, 0
v_mov_b32 v83, 0
v_mov_b32 v84, 0
v_mov_b32 v85, 0
v_mov_b32 v86, 0
v_mov_b32 v87, 0
v_mov_b32 v88, 0
v_mov_b32 v89, 0
v_mov_b32 v90, 0
v_mov_b32 v91, 0
v_mov_b32 v92, 0
v_mov_b32 v93, 0
v_mov_b32 v94, 0
v_mov_b32 v95, 0
v_mov_b32 v96, 0
v_mov_b32 v97, 0
v_mov_b32 v98, 0
v_mov_b32 v99, 0
v_mov_b32 v100, 0
v_mov_b32 v101, 0
v_mov_b32 v102, 0
v_mov_b32 v103, 0
v_mov_b32 v104, 0
v_mov_b32 v105, 0
v_mov_b32 v106, 0
v_mov_b32 v107, 0
v_mov_b32 v108, 0
v_mov_b32 v109, 0
v_mov_b32 v110, 0
v_mov_b32 v111, 0
v_mov_b32 v112, 0
v_mov_b32 v113, 0
v_mov_b32 v114, 0
v_mov_b32 v115, 0
v_mov_b32 v116, 0
v_mov_b32 v117, 0
v_mov_b32 v118, 0
v_mov_b32 v119, 0
v_mov_b32 v120, 0
v_mov_b32 v121, 0
v_mov_b32 v122, 0
v_mov_b32 v123, 0
v_mov_b32 v124, 0
v_mov_b32 v125, 0
v_mov_b32 v126, 0
v_mov_b32 v127, 0
s_waitcnt vmcnt(0)
v_lshlrev_b32 v21, 16, v21
v_lshlrev_b32 v22, 16, v22
v_lshlrev_b32 v23, 16, v23
v_mul_f32 v23, 1069066811, v23
v_exp_f32 v23, v23
s_nop 0
v_cvt_pk_bf16_f32 v23, v23, v23
v_lshlrev_b32 v23, 16, v23
v_mul_f32 v36, v23, v21
v_mul_f32 v37, v23, v22
v_mul_f32 v36, 1069066811, v36
v_exp_f32 v36, v36
v_mul_f32 v37, 0.15915494, v37
v_rndne_f32 v38, v37
v_sub_f32 v37, v37, v38
v_cos_f32 v24, v37
v_sin_f32 v25, v37
v_mul_f32 v24, v36, v24
v_mul_f32 v25, v36, v25
v_sub_f32 v26, 0, v25
v_add_f32 v36, -1.0, v24
v_mul_f32 v37, v21, v21
v_fmac_f32 v37, v22, v22
v_rcp_f32 v37, v37
v_mul_f32 v38, v36, v21
v_fmac_f32 v38, v25, v22
v_mul_f32 v39, v25, v21
v_fma_f32 v39, -v36, v22, v39
v_add_f32 v37, v37, v37
v_mul_f32 v28, v38, v37
v_mov_b32 v29, v28
v_mul_f32 v30, v39, v37
v_sub_f32 v30, 0, v30
v_mov_b32 v31, v30
v_sub_f32 v32, 0, v28
v_mov_b32 v33, v32
v_mov_b32 v40, v24
v_mov_b32 v41, v26
v_mul_f32 v36, v41, v41
v_mul_f32 v37, v41, v40
v_fma_f32 v36, v40, v40, -v36
v_fma_f32 v45, v40, v41, v37
v_mov_b32 v44, v36
v_mul_f32 v36, v45, v45
v_mul_f32 v37, v45, v44
v_fma_f32 v36, v44, v44, -v36
v_fma_f32 v45, v44, v45, v37
v_mov_b32 v44, v36
v_mul_f32 v36, v45, v45
v_mul_f32 v37, v45, v44
v_fma_f32 v36, v44, v44, -v36
v_fma_f32 v45, v44, v45, v37
v_mov_b32 v44, v36
v_mul_f32 v36, v45, v45
v_mul_f32 v37, v45, v44
v_fma_f32 v36, v44, v44, -v36
v_fma_f32 v45, v44, v45, v37
v_mov_b32 v44, v36
v_mul_f32 v36, v45, v45
v_mul_f32 v37, v45, v44
v_fma_f32 v36, v44, v44, -v36
v_fma_f32 v35, v44, v45, v37
v_mov_b32 v34, v36
s_cmp_lg_u32 s4, 0
s_cbranch_scc1 k1_t3_nopw
s_cmp_lg_u32 s7, 0
s_cbranch_scc1 k1_t3_nopw
s_add_u32 s64, s48, 10018816
s_addc_u32 s65, s49, 0
s_and_b32 s65, s65, 0xffff
s_mov_b32 s66, 41472
s_mov_b32 s67, 0x20000
v_lshlrev_b32 v20, 3, v1
s_mov_b32 s61, 0
buffer_store_dwordx2 v[40:41], v20, s[64:67], s61 offen
v_mul_f32 v36, v41, v45
v_mul_f32 v37, v41, v44
v_fma_f32 v36, v40, v44, -v36
v_fma_f32 v43, v40, v45, v37
v_mov_b32 v42, v36
s_nop 0
v_mov_b32 v40, v42
v_mov_b32 v41, v43
s_mov_b32 s61, 4608
buffer_store_dwordx2 v[40:41], v20, s[64:67], s61 offen
v_mul_f32 v36, v41, v45
v_mul_f32 v37, v41, v44
v_fma_f32 v36, v40, v44, -v36
v_fma_f32 v43, v40, v45, v37
v_mov_b32 v42, v36
s_nop 0
v_mov_b32 v40, v42
v_mov_b32 v41, v43
s_mov_b32 s61, 9216
buffer_store_dwordx2 v[40:41], v20, s[64:67], s61 offen
v_mul_f32 v36, v41, v45
v_mul_f32 v37, v41, v44
v_fma_f32 v36, v40, v44, -v36
v_fma_f32 v43, v40, v45, v37
v_mov_b32 v42, v36
s_nop 0
v_mov_b32 v40, v42
v_mov_b32 v41, v43
s_mov_b32 s61, 13824
buffer_store_dwordx2 v[40:41], v20, s[64:67], s61 offen
v_mul_f32 v36, v41, v45
v_mul_f32 v37, v41, v44
v_fma_f32 v36, v40, v44, -v36
v_fma_f32 v43, v40, v45, v37
v_mov_b32 v42, v36
s_nop 0
v_mov_b32 v40, v42
v_mov_b32 v41, v43
s_mov_b32 s61, 18432
buffer_store_dwordx2 v[40:41], v20, s[64:67], s61 offen
v_mul_f32 v36, v41, v45
v_mul_f32 v37, v41, v44
v_fma_f32 v36, v40, v44, -v36
v_fma_f32 v43, v40, v45, v37
v_mov_b32 v42, v36
s_nop 0
v_mov_b32 v40, v42
v_mov_b32 v41, v43
s_mov_b32 s61, 23040
buffer_store_dwordx2 v[40:41], v20, s[64:67], s61 offen
v_mul_f32 v36, v41, v45
v_mul_f32 v37, v41, v44
v_fma_f32 v36, v40, v44, -v36
v_fma_f32 v43, v40, v45, v37
v_mov_b32 v42, v36
s_nop 0
v_mov_b32 v40, v42
v_mov_b32 v41, v43
s_mov_b32 s61, 27648
buffer_store_dwordx2 v[40:41], v20, s[64:67], s61 offen
v_mul_f32 v36, v41, v45
v_mul_f32 v37, v41, v44
v_fma_f32 v36, v40, v44, -v36
v_fma_f32 v43, v40, v45, v37
v_mov_b32 v42, v36
s_nop 0
v_mov_b32 v40, v42
v_mov_b32 v41, v43
s_mov_b32 s61, 32256
buffer_store_dwordx2 v[40:41], v20, s[64:67], s61 offen
v_mul_f32 v36, v35, v35
v_mul_f32 v37, v35, v34
v_fma_f32 v36, v34, v34, -v36
v_fma_f32 v43, v34, v35, v37
v_mov_b32 v42, v36
v_mul_f32 v36, v43, v43
v_mul_f32 v37, v43, v42
v_fma_f32 v36, v42, v42, -v36
v_fma_f32 v43, v42, v43, v37
v_mov_b32 v42, v36
s_mov_b32 s61, 36864
buffer_store_dwordx2 v[42:43], v20, s[64:67], s61 offen
k1_t3_nopw:
s_add_u32 s64, s48, 4931584
s_addc_u32 s65, s49, 0
s_and_b32 s65, s65, 0xffff
s_mov_b32 s66, 5087232
s_mov_b32 s67, 0x20000
s_lshl_b32 s9, s4, 2
s_lshl_b32 s61, s7, 1
s_add_u32 s9, s9, s61
v_lshrrev_b32 v19, 5, v0
v_add_u32 v18, s9, v19
v_mul_u32_u24 v20, 4608, v18
v_add_u32 v20, v20, v1
v_lshlrev_b32 v20, 4, v20
v_mul_u32_u24 v21, 576, v18
v_add_u32 v21, v21, v1
v_lshlrev_b32 v21, 3, v21
s_mov_b32 s57, 1
s_mov_b32 s58, 0
s_waitcnt lgkmcnt(0)
s_barrier
ds_read_b128 v[128:131], v2 offset:0
ds_read_b128 v[136:139], v6 offset:16384
ds_read_b128 v[132:135], v2 offset:4096
ds_read_b128 v[140:143], v6 offset:24576
k1_t3_cl:
ds_read_b128 v[144:147], v3 offset:0
ds_read_b128 v[152:155], v7 offset:16384
ds_read_b128 v[148:151], v3 offset:4096
ds_read_b128 v[156:159], v7 offset:24576
s_waitcnt lgkmcnt(4)
v_mfma_f32_32x32x16_bf16 v[64:79], v[128:131], v[136:139], v[64:79]
v_mfma_f32_32x32x16_bf16 v[96:111], v[128:131], v[140:143], v[96:111]
v_mfma_f32_32x32x16_bf16 v[80:95], v[132:135], v[136:139], v[80:95]
v_mfma_f32_32x32x16_bf16 v[112:127], v[132:135], v[140:143], v[112:127]
ds_read_b128 v[128:131], v4 offset:0
ds_read_b128 v[136:139], v8 offset:16384
ds_read_b128 v[132:135], v4 offset:4096
ds_read_b128 v[140:143], v8 offset:24576
s_waitcnt lgkmcnt(4)
v_mfma_f32_32x32x16_bf16 v[64:79], v[144:147], v[152:155], v[64:79]
v_mfma_f32_32x32x16_bf16 v[96:111], v[144:147], v[156:159], v[96:111]
v_mfma_f32_32x32x16_bf16 v[80:95], v[148:151], v[152:155], v[80:95]
v_mfma_f32_32x32x16_bf16 v[112:127], v[148:151], v[156:159], v[112:127]
ds_read_b128 v[144:147], v5 offset:0
ds_read_b128 v[152:155], v9 offset:16384
ds_read_b128 v[148:151], v5 offset:4096
ds_read_b128 v[156:159], v9 offset:24576
s_add_u32 s58, s58, 1
s_cmp_eq_u32 s58, 4
s_cselect_b32 s58, 0, s58
s_mov_b32 s59, 32768
s_cselect_b32 s59, 4294868992, s59
v_add_u32 v2, s59, v2
v_add_u32 v3, s59, v3
v_add_u32 v4, s59, v4
v_add_u32 v5, s59, v5
v_add_u32 v6, s59, v6
v_add_u32 v7, s59, v7
v_add_u32 v8, s59, v8
v_add_u32 v9, s59, v9
s_waitcnt lgkmcnt(4)
v_mfma_f32_32x32x16_bf16 v[64:79], v[128:131], v[136:139], v[64:79]
v_mfma_f32_32x32x16_bf16 v[96:111], v[128:131], v[140:143], v[96:111]
v_mfma_f32_32x32x16_bf16 v[80:95], v[132:135], v[136:139], v[80:95]
v_mfma_f32_32x32x16_bf16 v[112:127], v[132:135], v[140:143], v[112:127]
s_waitcnt lgkmcnt(0)
s_cmp_eq_u32 s57, 9
s_cbranch_scc1 k1_t3_cx
s_add_u32 s57, s57, 1
s_barrier
ds_read_b128 v[128:131], v2 offset:0
ds_read_b128 v[136:139], v6 offset:16384
ds_read_b128 v[132:135], v2 offset:4096
ds_read_b128 v[140:143], v6 offset:24576
v_mfma_f32_32x32x16_bf16 v[64:79], v[144:147], v[152:155], v[64:79]
v_mfma_f32_32x32x16_bf16 v[96:111], v[144:147], v[156:159], v[96:111]
v_mfma_f32_32x32x16_bf16 v[80:95], v[148:151], v[152:155], v[80:95]
v_mfma_f32_32x32x16_bf16 v[112:127], v[148:151], v[156:159], v[112:127]
s_branch k1_t3_cl
k1_t3_cx:
v_mfma_f32_32x32x16_bf16 v[64:79], v[144:147], v[152:155], v[64:79]
v_mfma_f32_32x32x16_bf16 v[96:111], v[144:147], v[156:159], v[96:111]
v_mfma_f32_32x32x16_bf16 v[80:95], v[148:151], v[152:155], v[80:95]
v_mfma_f32_32x32x16_bf16 v[112:127], v[148:151], v[156:159], v[112:127]
s_nop 8
v_fmac_f32 v65, v24, v64
v_fmac_f32 v97, v24, v96
v_fmac_f32 v65, v26, v96
v_fmac_f32 v97, v25, v64
v_fmac_f32 v66, v24, v65
v_fmac_f32 v98, v24, v97
v_fmac_f32 v66, v26, v97
v_fmac_f32 v98, v25, v65
v_fmac_f32 v67, v24, v66
v_fmac_f32 v99, v24, v98
v_fmac_f32 v67, v26, v98
v_fmac_f32 v99, v25, v66
v_fmac_f32 v68, v24, v67
v_fmac_f32 v100, v24, v99
v_fmac_f32 v68, v26, v99
v_fmac_f32 v100, v25, v67
v_fmac_f32 v69, v24, v68
v_fmac_f32 v101, v24, v100
v_fmac_f32 v69, v26, v100
v_fmac_f32 v101, v25, v68
v_fmac_f32 v70, v24, v69
v_fmac_f32 v102, v24, v101
v_fmac_f32 v70, v26, v101
v_fmac_f32 v102, v25, v69
v_fmac_f32 v71, v24, v70
v_fmac_f32 v103, v24, v102
v_fmac_f32 v71, v26, v102
v_fmac_f32 v103, v25, v70
v_fmac_f32 v72, v24, v71
v_fmac_f32 v104, v24, v103
v_fmac_f32 v72, v26, v103
v_fmac_f32 v104, v25, v71
v_fmac_f32 v73, v24, v72
v_fmac_f32 v105, v24, v104
v_fmac_f32 v73, v26, v104
v_fmac_f32 v105, v25, v72
v_fmac_f32 v74, v24, v73
v_fmac_f32 v106, v24, v105
v_fmac_f32 v74, v26, v105
v_fmac_f32 v106, v25, v73
v_fmac_f32 v75, v24, v74
v_fmac_f32 v107, v24, v106
v_fmac_f32 v75, v26, v106
v_fmac_f32 v107, v25, v74
v_fmac_f32 v76, v24, v75
v_fmac_f32 v108, v24, v107
v_fmac_f32 v76, v26, v107
v_fmac_f32 v108, v25, v75
v_fmac_f32 v77, v24, v76
v_fmac_f32 v109, v24, v108
v_fmac_f32 v77, v26, v108
v_fmac_f32 v109, v25, v76
v_fmac_f32 v78, v24, v77
v_fmac_f32 v110, v24, v109
v_fmac_f32 v78, v26, v109
v_fmac_f32 v110, v25, v77
v_fmac_f32 v79, v24, v78
v_fmac_f32 v111, v24, v110
v_fmac_f32 v79, v26, v110
v_fmac_f32 v111, v25, v78
v_fmac_f32 v80, v24, v79
v_fmac_f32 v112, v24, v111
v_fmac_f32 v80, v26, v111
v_fmac_f32 v112, v25, v79
v_fmac_f32 v81, v24, v80
v_fmac_f32 v113, v24, v112
v_fmac_f32 v81, v26, v112
v_fmac_f32 v113, v25, v80
v_fmac_f32 v82, v24, v81
v_fmac_f32 v114, v24, v113
v_fmac_f32 v82, v26, v113
v_fmac_f32 v114, v25, v81
v_fmac_f32 v83, v24, v82
v_fmac_f32 v115, v24, v114
v_fmac_f32 v83, v26, v114
v_fmac_f32 v115, v25, v82
v_fmac_f32 v84, v24, v83
v_fmac_f32 v116, v24, v115
v_fmac_f32 v84, v26, v115
v_fmac_f32 v116, v25, v83
v_fmac_f32 v85, v24, v84
v_fmac_f32 v117, v24, v116
v_fmac_f32 v85, v26, v116
v_fmac_f32 v117, v25, v84
v_fmac_f32 v86, v24, v85
v_fmac_f32 v118, v24, v117
v_fmac_f32 v86, v26, v117
v_fmac_f32 v118, v25, v85
v_fmac_f32 v87, v24, v86
v_fmac_f32 v119, v24, v118
v_fmac_f32 v87, v26, v118
v_fmac_f32 v119, v25, v86
v_fmac_f32 v88, v24, v87
v_fmac_f32 v120, v24, v119
v_fmac_f32 v88, v26, v119
v_fmac_f32 v120, v25, v87
v_fmac_f32 v89, v24, v88
v_fmac_f32 v121, v24, v120
v_fmac_f32 v89, v26, v120
v_fmac_f32 v121, v25, v88
v_fmac_f32 v90, v24, v89
v_fmac_f32 v122, v24, v121
v_fmac_f32 v90, v26, v121
v_fmac_f32 v122, v25, v89
v_fmac_f32 v91, v24, v90
v_fmac_f32 v123, v24, v122
v_fmac_f32 v91, v26, v122
v_fmac_f32 v123, v25, v90
v_fmac_f32 v92, v24, v91
v_fmac_f32 v124, v24, v123
v_fmac_f32 v92, v26, v123
v_fmac_f32 v124, v25, v91
v_fmac_f32 v93, v24, v92
v_fmac_f32 v125, v24, v124
v_fmac_f32 v93, v26, v124
v_fmac_f32 v125, v25, v92
v_fmac_f32 v94, v24, v93
v_fmac_f32 v126, v24, v125
v_fmac_f32 v94, v26, v125
v_fmac_f32 v126, v25, v93
v_fmac_f32 v95, v24, v94
v_fmac_f32 v127, v24, v126
v_fmac_f32 v95, v26, v126
v_fmac_f32 v127, v25, v94
v_pk_mul_f32 v[36:37], v[96:97], v[30:31]
v_pk_mul_f32 v[38:39], v[64:65], v[30:31]
v_pk_fma_f32 v[36:37], v[64:65], v[28:29], v[36:37]
v_pk_fma_f32 v[38:39], v[96:97], v[32:33], v[38:39]
v_cvt_pk_bf16_f32 v128, v36, v37
v_cvt_pk_bf16_f32 v144, v38, v39
v_pk_mul_f32 v[36:37], v[98:99], v[30:31]
v_pk_mul_f32 v[38:39], v[66:67], v[30:31]
v_pk_fma_f32 v[36:37], v[66:67], v[28:29], v[36:37]
v_pk_fma_f32 v[38:39], v[98:99], v[32:33], v[38:39]
v_cvt_pk_bf16_f32 v129, v36, v37
v_cvt_pk_bf16_f32 v145, v38, v39
v_pk_mul_f32 v[36:37], v[100:101], v[30:31]
v_pk_mul_f32 v[38:39], v[68:69], v[30:31]
v_pk_fma_f32 v[36:37], v[68:69], v[28:29], v[36:37]
v_pk_fma_f32 v[38:39], v[100:101], v[32:33], v[38:39]
v_cvt_pk_bf16_f32 v130, v36, v37
v_cvt_pk_bf16_f32 v146, v38, v39
v_pk_mul_f32 v[36:37], v[102:103], v[30:31]
v_pk_mul_f32 v[38:39], v[70:71], v[30:31]
v_pk_fma_f32 v[36:37], v[70:71], v[28:29], v[36:37]
v_pk_fma_f32 v[38:39], v[102:103], v[32:33], v[38:39]
v_cvt_pk_bf16_f32 v131, v36, v37
v_cvt_pk_bf16_f32 v147, v38, v39
s_mov_b32 s61, 0
buffer_store_dwordx4 v[128:131], v20, s[64:67], s61 offen
s_mov_b32 s61, 9216
buffer_store_dwordx4 v[144:147], v20, s[64:67], s61 offen
v_pk_mul_f32 v[36:37], v[104:105], v[30:31]
v_pk_mul_f32 v[38:39], v[72:73], v[30:31]
v_pk_fma_f32 v[36:37], v[72:73], v[28:29], v[36:37]
v_pk_fma_f32 v[38:39], v[104:105], v[32:33], v[38:39]
v_cvt_pk_bf16_f32 v132, v36, v37
v_cvt_pk_bf16_f32 v148, v38, v39
v_pk_mul_f32 v[36:37], v[106:107], v[30:31]
v_pk_mul_f32 v[38:39], v[74:75], v[30:31]
v_pk_fma_f32 v[36:37], v[74:75], v[28:29], v[36:37]
v_pk_fma_f32 v[38:39], v[106:107], v[32:33], v[38:39]
v_cvt_pk_bf16_f32 v133, v36, v37
v_cvt_pk_bf16_f32 v149, v38, v39
v_pk_mul_f32 v[36:37], v[108:109], v[30:31]
v_pk_mul_f32 v[38:39], v[76:77], v[30:31]
v_pk_fma_f32 v[36:37], v[76:77], v[28:29], v[36:37]
v_pk_fma_f32 v[38:39], v[108:109], v[32:33], v[38:39]
v_cvt_pk_bf16_f32 v134, v36, v37
v_cvt_pk_bf16_f32 v150, v38, v39
v_pk_mul_f32 v[36:37], v[110:111], v[30:31]
v_pk_mul_f32 v[38:39], v[78:79], v[30:31]
v_pk_fma_f32 v[36:37], v[78:79], v[28:29], v[36:37]
v_pk_fma_f32 v[38:39], v[110:111], v[32:33], v[38:39]
v_cvt_pk_bf16_f32 v135, v36, v37
v_cvt_pk_bf16_f32 v151, v38, v39
s_mov_b32 s61, 18432
buffer_store_dwordx4 v[132:135], v20, s[64:67], s61 offen
s_mov_b32 s61, 27648
buffer_store_dwordx4 v[148:151], v20, s[64:67], s61 offen
v_pk_mul_f32 v[36:37], v[112:113], v[30:31]
v_pk_mul_f32 v[38:39], v[80:81], v[30:31]
v_pk_fma_f32 v[36:37], v[80:81], v[28:29], v[36:37]
v_pk_fma_f32 v[38:39], v[112:113], v[32:33], v[38:39]
v_cvt_pk_bf16_f32 v136, v36, v37
v_cvt_pk_bf16_f32 v152, v38, v39
v_pk_mul_f32 v[36:37], v[114:115], v[30:31]
v_pk_mul_f32 v[38:39], v[82:83], v[30:31]
v_pk_fma_f32 v[36:37], v[82:83], v[28:29], v[36:37]
v_pk_fma_f32 v[38:39], v[114:115], v[32:33], v[38:39]
v_cvt_pk_bf16_f32 v137, v36, v37
v_cvt_pk_bf16_f32 v153, v38, v39
v_pk_mul_f32 v[36:37], v[116:117], v[30:31]
v_pk_mul_f32 v[38:39], v[84:85], v[30:31]
v_pk_fma_f32 v[36:37], v[84:85], v[28:29], v[36:37]
v_pk_fma_f32 v[38:39], v[116:117], v[32:33], v[38:39]
v_cvt_pk_bf16_f32 v138, v36, v37
v_cvt_pk_bf16_f32 v154, v38, v39
v_pk_mul_f32 v[36:37], v[118:119], v[30:31]
v_pk_mul_f32 v[38:39], v[86:87], v[30:31]
v_pk_fma_f32 v[36:37], v[86:87], v[28:29], v[36:37]
v_pk_fma_f32 v[38:39], v[118:119], v[32:33], v[38:39]
v_cvt_pk_bf16_f32 v139, v36, v37
v_cvt_pk_bf16_f32 v155, v38, v39
s_mov_b32 s61, 36864
buffer_store_dwordx4 v[136:139], v20, s[64:67], s61 offen
s_mov_b32 s61, 46080
buffer_store_dwordx4 v[152:155], v20, s[64:67], s61 offen
v_pk_mul_f32 v[36:37], v[120:121], v[30:31]
v_pk_mul_f32 v[38:39], v[88:89], v[30:31]
v_pk_fma_f32 v[36:37], v[88:89], v[28:29], v[36:37]
v_pk_fma_f32 v[38:39], v[120:121], v[32:33], v[38:39]
v_cvt_pk_bf16_f32 v140, v36, v37
v_cvt_pk_bf16_f32 v156, v38, v39
v_pk_mul_f32 v[36:37], v[122:123], v[30:31]
v_pk_mul_f32 v[38:39], v[90:91], v[30:31]
v_pk_fma_f32 v[36:37], v[90:91], v[28:29], v[36:37]
v_pk_fma_f32 v[38:39], v[122:123], v[32:33], v[38:39]
v_cvt_pk_bf16_f32 v141, v36, v37
v_cvt_pk_bf16_f32 v157, v38, v39
v_pk_mul_f32 v[36:37], v[124:125], v[30:31]
v_pk_mul_f32 v[38:39], v[92:93], v[30:31]
v_pk_fma_f32 v[36:37], v[92:93], v[28:29], v[36:37]
v_pk_fma_f32 v[38:39], v[124:125], v[32:33], v[38:39]
v_cvt_pk_bf16_f32 v142, v36, v37
v_cvt_pk_bf16_f32 v158, v38, v39
v_pk_mul_f32 v[36:37], v[126:127], v[30:31]
v_pk_mul_f32 v[38:39], v[94:95], v[30:31]
v_pk_fma_f32 v[36:37], v[94:95], v[28:29], v[36:37]
v_pk_fma_f32 v[38:39], v[126:127], v[32:33], v[38:39]
v_cvt_pk_bf16_f32 v143, v36, v37
v_cvt_pk_bf16_f32 v159, v38, v39
s_mov_b32 s61, 55296
buffer_store_dwordx4 v[140:143], v20, s[64:67], s61 offen
s_mov_b32 s61, 64512
buffer_store_dwordx4 v[156:159], v20, s[64:67], s61 offen
v_mov_b32 v40, v37
v_mov_b32 v41, v39
v_and_b32 v22, 31, v0
s_lshl_b32 s61, s8, 5
v_add_u32 v22, s61, v22
v_lshlrev_b32 v22, 5, v22
v_add_u32 v22, 0x20000, v22
s_lshl_b32 s61, s7, 4
v_lshl_add_u32 v23, v19, 3, v22
v_add_u32 v23, s61, v23
ds_write_b64 v23, v[40:41]
s_waitcnt lgkmcnt(0)
s_barrier
ds_read_b128 v[48:51], v22
ds_read_b128 v[52:55], v22 offset:16
v_cmp_eq_u32 vcc, 1, v19
s_waitcnt lgkmcnt(0)
s_cmp_eq_u32 s7, 1
s_cbranch_scc1 k1_t3_th1
v_cndmask_b32 v56, 0, v48, vcc
v_cndmask_b32 v57, 0, v49, vcc
s_mov_b32 s61, 4718592
buffer_store_dwordx2 v[56:57], v21, s[64:67], s61 offen
s_endpgm
k1_t3_th1:
v_fma_f32 v56, v34, v48, v50
v_fma_f32 v57, v34, v49, v51
v_fma_f32 v56, -v35, v49, v56
v_fma_f32 v57, v35, v48, v57
v_fma_f32 v58, v34, v56, v52
v_fma_f32 v59, v34, v57, v53
v_fma_f32 v58, -v35, v57, v58
v_fma_f32 v59, v35, v56, v59
v_fma_f32 v60, v34, v58, v54
v_fma_f32 v61, v34, v59, v55
v_fma_f32 v60, -v35, v59, v60
v_fma_f32 v61, v35, v58, v61
v_cndmask_b32 v56, v56, v58, vcc
v_cndmask_b32 v57, v57, v59, vcc
s_mov_b32 s61, 4718592
buffer_store_dwordx2 v[56:57], v21, s[64:67], s61 offen
s_lshr_b32 s61, s4, 1
s_mul_i32 s61, s61, 9216
s_and_b32 s62, s4, 1
s_lshl_b32 s62, s62, 3
s_add_u32 s61, s61, s62
s_add_u32 s61, s61, 5013504
v_lshlrev_b32 v22, 4, v1
buffer_store_dwordx2 v[60:61], v22, s[64:67], s61 offen
k1_kernel_end:
s_endpgm
.globl k2_kernel
.p2align 8
.type k2_kernel,@function
k2_kernel:
s_cmp_ge_u32 s2, 256
s_cbranch_scc1 k2_kernel_end
s_load_dwordx16 s[16:31], s[0:1], 0
s_load_dwordx16 s[32:47], s[0:1], 64
s_load_dwordx2 s[48:49], s[0:1], 128
v_lshrrev_b32 v1, 6, v0
v_and_b32 v0, 63, v0
v_readfirstlane_b32 s3, v1
v_and_b32 v14, 31, v0
v_lshrrev_b32 v15, 5, v0
v_lshrrev_b32 v2, 2, v14
v_mul_u32_u24 v2, 1152, v2
v_and_b32 v1, 3, v0
v_mad_u32_u24 v2, v1, 36, v2
v_lshlrev_b32 v1, 28, v15
v_add3_u32 v3, v2, v1, 32
v_xor_b32 v4, 0x10000000, v3
v_lshl_add_u32 v2, v15, 4, v2
v_lshlrev_b32 v5, 4, v0
v_cmp_lt_u32 vcc, 20, v14
v_mov_b32 v1, 0x10000000
s_nop 0
v_cndmask_b32 v6, v5, v1, vcc
v_mov_b32 v13, 0
s_and_b32 s7, s2, 3
s_mul_i32 s5, s7, 9
s_add_u32 s5, s5, 1
s_lshr_b32 s5, s5, 1
s_and_b32 s7, s7, 1
s_lshl_b32 s7, s7, 5
s_add_u32 s7, s7, 8
s_cmp_eq_u32 s3, 0
s_cselect_b32 s7, s7, s3
s_add_u32 s5, s5, s7
s_sub_u32 s5, s5, 4
s_cmp_lt_u32 s7, 4
s_cselect_b32 s5, 99, s5
s_lshr_b32 s7, s3, 2
s_mul_i32 s9, s7, 36864
s_lshr_b32 s10, s2, 2
s_mul_i32 s11, s10, 73728
s_add_u32 s11, s11, s9
s_add_u32 s11, s11, 6459392
v_add_u32 v248, s11, v5
s_lshl_b32 s10, s10, 7
s_add_u32 s10, s10, 11177984
v_min_u32 v250, 17, v0
v_lshl_add_u32 v250, v250, 2, s10
s_and_b32 s10, s2, 3
s_lshl_b32 s10, s10, 2
s_and_b32 s11, s3, 3
s_add_u32 s10, s10, s11
s_mul_i32 s10, s10, 73728
s_add_u32 s10, s10, s9
s_add_u32 s10, s10, 5132288
s_lshl_b32 s7, s7, 8
v_xor_b32 v249, s7, v5
v_add_u32 v249, s10, v249
s_mul_i32 s8, s2, 9216
s_lshl_b32 s13, s3, 13
s_lshl_b32 s14, s3, 14
s_add_u32 s14, s14, 81920
s_lshl_b32 s15, s3, 11
s_add_u32 s15, s15, 65536
s_mul_i32 s9, s3, 18032
s_add_u32 s9, s9, 2576
v_add_u32 v7, s9, v5
v_lshlrev_b32 v1, 3, v0
s_add_u32 s9, s9, 2048
v_add_u32 v8, s9, v1
s_add_u32 s10, s3, 2
s_and_b32 s10, s10, 7
s_mul_i32 s10, s10, 18032
s_add_u32 s12, s3, 1
s_and_b32 s12, s12, 7
s_mul_i32 s12, s12, 18032
s_sub_u32 s12, s12, s10
s_add_u32 s10, s10, 2576
v_add_u32 v9, s10, v5
s_add_u32 s10, s10, 2048
v_add_u32 v10, s10, v1
v_mul_u32_u24 v1, 2576, v0
v_add_u32 v1, s9, v1
v_mov_b32 v11, 0
s_mov_b64 exec, 0x7f
ds_write_b32 v1, v11 offset:512
s_lshl_b32 s9, s3, 2
v_mov_b32 v1, s9
ds_write_b32 v1, v11
s_mov_b64 exec, -1
v_mov_b32 v11, 1
s_waitcnt lgkmcnt(0)
s_barrier
s_mov_b32 s52, s48
s_and_b32 s53, s49, 0xffff
s_mov_b32 s54, 2359296
s_mov_b32 s55, 0x20000
s_add_u32 s56, s48, 4718592
s_addc_u32 s57, s49, 0
s_and_b32 s57, s57, 0xffff
s_mov_b32 s58, 212992
s_mov_b32 s59, 0x20000
s_add_u32 s60, s48, 4931584
s_addc_u32 s61, s49, 0
s_and_b32 s61, s61, 0xffff
s_mov_b32 s62, 11857920
s_mov_b32 s63, 0x20000
s_add_u32 s64, s48, 2359296
s_addc_u32 s65, s49, 0
s_and_b32 s65, s65, 0xffff
s_mov_b32 s66, 2359296
s_mov_b32 s67, 0x20000
s_cmp_ge_u32 s5, 18
s_cbranch_scc1 k2_nofx1
s_lshr_b32 s7, s2, 2
s_mov_b32 s9, s5
s_cmp_ge_u32 s9, 9
s_cselect_b32 s10, 1, 0
s_mul_i32 s11, s10, 9
s_sub_u32 s9, s9, s11
s_lshl_b32 s70, s9, 12
s_lshl_b32 s11, s10, 8
s_add_u32 s70, s70, s11
s_mul_i32 s11, s7, 73728
s_add_u32 s70, s70, s11
s_add_u32 s70, s70, 6459392
s_lshl_b32 s9, s9, 6
v_add_u32 v13, s9, v0
v_lshlrev_b32 v14, 3, v13
v_lshlrev_b32 v13, 4, v13
s_lshr_b32 s68, s7, 2
s_mov_b32 s11, 5124096
buffer_load_dwordx2 v[222:223], v14, s[60:63], s11 offen
s_cmp_le_u32 s68, 0
s_cbranch_scc1 k2_fx_ld
s_mov_b32 s11, 5013504
buffer_load_dwordx4 v[120:123], v13, s[60:63], s11 offen
s_cmp_le_u32 s68, 2
s_cbranch_scc1 k2_fx_ld
s_mov_b32 s11, 5022720
buffer_load_dwordx4 v[124:127], v13, s[60:63], s11 offen
s_cmp_le_u32 s68, 4
s_cbranch_scc1 k2_fx_ld
s_mov_b32 s11, 5031936
buffer_load_dwordx4 v[128:131], v13, s[60:63], s11 offen
s_cmp_le_u32 s68, 6
s_cbranch_scc1 k2_fx_ld
s_mov_b32 s11, 5041152
buffer_load_dwordx4 v[132:135], v13, s[60:63], s11 offen
s_cmp_le_u32 s68, 8
s_cbranch_scc1 k2_fx_ld
s_mov_b32 s11, 5050368
buffer_load_dwordx4 v[136:139], v13, s[60:63], s11 offen
s_cmp_le_u32 s68, 10
s_cbranch_scc1 k2_fx_ld
s_mov_b32 s11, 5059584
buffer_load_dwordx4 v[140:143], v13, s[60:63], s11 offen
s_cmp_le_u32 s68, 12
s_cbranch_scc1 k2_fx_ld
s_mov_b32 s11, 5068800
buffer_load_dwordx4 v[144:147], v13, s[60:63], s11 offen
s_cmp_le_u32 s68, 14
s_cbranch_scc1 k2_fx_ld
s_mov_b32 s11, 5078016
buffer_load_dwordx4 v[148:151], v13, s[60:63], s11 offen
k2_fx_ld:
s_mov_b32 s11, 5087232
buffer_load_dwordx2 v[216:217], v14, s[60:63], s11 offen
s_mul_i32 s9, s10, 4608
s_add_u32 s11, s11, s9
buffer_load_dwordx2 v[218:219], v14, s[60:63], s11 offen
s_and_b32 s9, s7, 3
s_mul_i32 s9, s9, 9216
s_add_u32 s11, s11, s9
buffer_load_dwordx2 v[220:221], v14, s[60:63], s11 offen
s_mul_i32 s11, s7, 4608
s_add_u32 s11, s11, 4718592
buffer_load_dwordx2 v[224:225], v14, s[60:63], s11 offen
s_lshl_b32 s6, s7, 1
s_add_u32 s6, s6, s10
s_mul_i32 s6, s6, 36864
s_add_u32 s11, s6, 0
buffer_load_dwordx4 v[200:203], v13, s[60:63], s11 offen
s_add_u32 s11, s6, 9216
buffer_load_dwordx4 v[204:207], v13, s[60:63], s11 offen
s_add_u32 s11, s6, 18432
buffer_load_dwordx4 v[208:211], v13, s[60:63], s11 offen
s_add_u32 s11, s6, 27648
buffer_load_dwordx4 v[212:215], v13, s[60:63], s11 offen
k2_nofx1:
buffer_load_dwordx4 v[16:19], v5, s[56:59], s15 offen
buffer_load_dwordx4 v[20:23], v5, s[56:59], s15 offen offset:1024
s_mul_i32 s9, s3, 144
s_add_u32 s9, s9, s8
buffer_load_dwordx4 v[184:187], v2, s[52:55], s9 offen
buffer_load_dword v188, v3, s[52:55], s9 offen
buffer_load_dword v190, v4, s[52:55], s9 offen
s_add_u32 s7, s13, 0
buffer_load_dwordx4 v[24:27], v5, s[56:59], s7 offen offset:0
s_add_u32 s7, s13, 0
buffer_load_dwordx4 v[28:31], v5, s[56:59], s7 offen offset:1024
s_add_u32 s7, s14, 0
buffer_load_dwordx4 v[56:59], v6, s[56:59], s7 offen offset:0
buffer_load_dwordx4 v[60:63], v6, s[56:59], s7 offen offset:1024
s_add_u32 s7, s13, 0
buffer_load_dwordx4 v[32:35], v5, s[56:59], s7 offen offset:2048
s_add_u32 s7, s14, 0
buffer_load_dwordx4 v[64:67], v6, s[56:59], s7 offen offset:2048
buffer_load_dwordx4 v[68:71], v6, s[56:59], s7 offen offset:3072
v_mov_b32 v189, 0
v_mov_b32 v191, 0
v_mov_b32 v197, 0
v_mov_b32 v199, 0
v_mov_b32 v152, 0
v_mov_b32 v153, 0
v_mov_b32 v154, 0
v_mov_b32 v155, 0
v_mov_b32 v156, 0
v_mov_b32 v157, 0
v_mov_b32 v158, 0
v_mov_b32 v159, 0
v_mov_b32 v160, 0
v_mov_b32 v161, 0
v_mov_b32 v162, 0
v_mov_b32 v163, 0
v_mov_b32 v164, 0
v_mov_b32 v165, 0
v_mov_b32 v166, 0
v_mov_b32 v167, 0
v_mov_b32 v168, 0
v_mov_b32 v169, 0
v_mov_b32 v170, 0
v_mov_b32 v171, 0
v_mov_b32 v172, 0
v_mov_b32 v173, 0
v_mov_b32 v174, 0
v_mov_b32 v175, 0
v_mov_b32 v176, 0
v_mov_b32 v177, 0
v_mov_b32 v178, 0
v_mov_b32 v179, 0
v_mov_b32 v180, 0
v_mov_b32 v181, 0
v_mov_b32 v182, 0
v_mov_b32 v183, 0
s_mov_b32 s4, 0
s_add_u32 s69, s3, 1
s_cmp_ge_u32 s5, 18
s_cbranch_scc1 k2_nofx2
v_mov_b32 v226, 0
v_mov_b32 v227, 0
s_mov_b32 s10, 0x3f80
s_mov_b32 s11, 0x3f800000
s_waitcnt vmcnt(20)
s_cmp_le_u32 s68, 0
s_cbranch_scc1 k2_fx_h
v_pk_fma_f32 v[232:233], v[226:227], v[222:223], v[120:121] op_sel_hi:[1,0,1]
v_pk_fma_f32 v[226:227], v[226:227], v[222:223], v[232:233] op_sel:[1,1,0] op_sel_hi:[0,1,1] neg_lo:[0,1,0]
s_cmp_le_u32 s68, 1
s_cbranch_scc1 k2_fx_h
v_pk_fma_f32 v[232:233], v[226:227], v[222:223], v[122:123] op_sel_hi:[1,0,1]
v_pk_fma_f32 v[226:227], v[226:227], v[222:223], v[232:233] op_sel:[1,1,0] op_sel_hi:[0,1,1] neg_lo:[0,1,0]
s_cmp_le_u32 s68, 2
s_cbranch_scc1 k2_fx_h
v_pk_fma_f32 v[232:233], v[226:227], v[222:223], v[124:125] op_sel_hi:[1,0,1]
v_pk_fma_f32 v[226:227], v[226:227], v[222:223], v[232:233] op_sel:[1,1,0] op_sel_hi:[0,1,1] neg_lo:[0,1,0]
s_cmp_le_u32 s68, 3
s_cbranch_scc1 k2_fx_h
v_pk_fma_f32 v[232:233], v[226:227], v[222:223], v[126:127] op_sel_hi:[1,0,1]
v_pk_fma_f32 v[226:227], v[226:227], v[222:223], v[232:233] op_sel:[1,1,0] op_sel_hi:[0,1,1] neg_lo:[0,1,0]
s_cmp_le_u32 s68, 4
s_cbranch_scc1 k2_fx_h
v_pk_fma_f32 v[232:233], v[226:227], v[222:223], v[128:129] op_sel_hi:[1,0,1]
v_pk_fma_f32 v[226:227], v[226:227], v[222:223], v[232:233] op_sel:[1,1,0] op_sel_hi:[0,1,1] neg_lo:[0,1,0]
s_cmp_le_u32 s68, 5
s_cbranch_scc1 k2_fx_h
v_pk_fma_f32 v[232:233], v[226:227], v[222:223], v[130:131] op_sel_hi:[1,0,1]
v_pk_fma_f32 v[226:227], v[226:227], v[222:223], v[232:233] op_sel:[1,1,0] op_sel_hi:[0,1,1] neg_lo:[0,1,0]
s_cmp_le_u32 s68, 6
s_cbranch_scc1 k2_fx_h
v_pk_fma_f32 v[232:233], v[226:227], v[222:223], v[132:133] op_sel_hi:[1,0,1]
v_pk_fma_f32 v[226:227], v[226:227], v[222:223], v[232:233] op_sel:[1,1,0] op_sel_hi:[0,1,1] neg_lo:[0,1,0]
s_cmp_le_u32 s68, 7
s_cbranch_scc1 k2_fx_h
v_pk_fma_f32 v[232:233], v[226:227], v[222:223], v[134:135] op_sel_hi:[1,0,1]
v_pk_fma_f32 v[226:227], v[226:227], v[222:223], v[232:233] op_sel:[1,1,0] op_sel_hi:[0,1,1] neg_lo:[0,1,0]
s_cmp_le_u32 s68, 8
s_cbranch_scc1 k2_fx_h
v_pk_fma_f32 v[232:233], v[226:227], v[222:223], v[136:137] op_sel_hi:[1,0,1]
v_pk_fma_f32 v[226:227], v[226:227], v[222:223], v[232:233] op_sel:[1,1,0] op_sel_hi:[0,1,1] neg_lo:[0,1,0]
s_cmp_le_u32 s68, 9
s_cbranch_scc1 k2_fx_h
v_pk_fma_f32 v[232:233], v[226:227], v[222:223], v[138:139] op_sel_hi:[1,0,1]
v_pk_fma_f32 v[226:227], v[226:227], v[222:223], v[232:233] op_sel:[1,1,0] op_sel_hi:[0,1,1] neg_lo:[0,1,0]
s_cmp_le_u32 s68, 10
s_cbranch_scc1 k2_fx_h
v_pk_fma_f32 v[232:233], v[226:227], v[222:223], v[140:141] op_sel_hi:[1,0,1]
v_pk_fma_f32 v[226:227], v[226:227], v[222:223], v[232:233] op_sel:[1,1,0] op_sel_hi:[0,1,1] neg_lo:[0,1,0]
s_cmp_le_u32 s68, 11
s_cbranch_scc1 k2_fx_h
v_pk_fma_f32 v[232:233], v[226:227], v[222:223], v[142:143] op_sel_hi:[1,0,1]
v_pk_fma_f32 v[226:227], v[226:227], v[222:223], v[232:233] op_sel:[1,1,0] op_sel_hi:[0,1,1] neg_lo:[0,1,0]
s_cmp_le_u32 s68, 12
s_cbranch_scc1 k2_fx_h
v_pk_fma_f32 v[232:233], v[226:227], v[222:223], v[144:145] op_sel_hi:[1,0,1]
v_pk_fma_f32 v[226:227], v[226:227], v[222:223], v[232:233] op_sel:[1,1,0] op_sel_hi:[0,1,1] neg_lo:[0,1,0]
s_cmp_le_u32 s68, 13
s_cbranch_scc1 k2_fx_h
v_pk_fma_f32 v[232:233], v[226:227], v[222:223], v[146:147] op_sel_hi:[1,0,1]
v_pk_fma_f32 v[226:227], v[226:227], v[222:223], v[232:233] op_sel:[1,1,0] op_sel_hi:[0,1,1] neg_lo:[0,1,0]
s_cmp_le_u32 s68, 14
s_cbranch_scc1 k2_fx_h
v_pk_fma_f32 v[232:233], v[226:227], v[222:223], v[148:149] op_sel_hi:[1,0,1]
v_pk_fma_f32 v[226:227], v[226:227], v[222:223], v[232:233] op_sel:[1,1,0] op_sel_hi:[0,1,1] neg_lo:[0,1,0]
k2_fx_h:
s_add_u32 s7, s13, 0
buffer_load_dwordx4 v[36:39], v5, s[56:59], s7 offen offset:3072
s_add_u32 s7, s14, 4096
buffer_load_dwordx4 v[72:75], v6, s[56:59], s7 offen offset:0
buffer_load_dwordx4 v[76:79], v6, s[56:59], s7 offen offset:1024
v_bfe_u32 v14, v0, 1, 1
v_lshlrev_b32 v14, 10, v14
v_lshrrev_b32 v15, 4, v0
v_lshlrev_b32 v15, 3, v15
v_bfe_u32 v1, v0, 2, 2
v_add_u32 v15, v15, v1
v_lshl_add_u32 v14, v15, 4, v14
v_and_b32 v1, 1, v0
v_lshl_add_u32 v14, v1, 3, v14
s_mul_i32 s7, s3, 18032
s_add_u32 s7, s7, 15456
v_add_u32 v14, s7, v14
v_and_b32 v15, 15, v0
v_lshlrev_b32 v15, 4, v15
v_bfe_u32 v1, v0, 4, 1
v_lshl_add_u32 v15, v1, 9, v15
v_lshrrev_b32 v1, 5, v0
v_lshl_add_u32 v15, v1, 10, v15
s_waitcnt vmcnt(19)
v_pk_mul_f32 v[228:229], v[224:225], v[218:219] op_sel_hi:[1,0]
v_pk_fma_f32 v[228:229], v[224:225], v[218:219], v[228:229] op_sel:[1,1,0] op_sel_hi:[0,1,1] neg_lo:[0,1,0]
v_pk_mul_f32 v[222:223], v[216:217], v[216:217] op_sel_hi:[1,0]
v_pk_fma_f32 v[222:223], v[216:217], v[216:217], v[222:223] op_sel:[1,1,0] op_sel_hi:[0,1,1] neg_lo:[0,1,0]
v_pk_fma_f32 v[232:233], v[226:227], v[220:221], v[228:229] op_sel_hi:[1,0,1]
v_pk_fma_f32 v[228:229], v[226:227], v[220:221], v[232:233] op_sel:[1,1,0] op_sel_hi:[0,1,1] neg_lo:[0,1,0]
v_pk_mul_f32 v[230:231], v[228:229], v[216:217] op_sel_hi:[1,0]
v_pk_fma_f32 v[230:231], v[228:229], v[216:217], v[230:231] op_sel:[1,1,0] op_sel_hi:[0,1,1] neg_lo:[0,1,0]
s_waitcnt vmcnt(15)
v_dot2_f32_bf16 v232, v200, s10, v228
v_dot2_f32_bf16 v233, v200, s11, v230
v_dot2_f32_bf16 v234, v204, s10, v229
v_dot2_f32_bf16 v235, v204, s11, v231
v_pk_mul_f32 v[236:237], v[228:229], v[222:223] op_sel_hi:[1,0]
v_pk_mul_f32 v[238:239], v[230:231], v[222:223] op_sel_hi:[1,0]
v_cvt_pk_bf16_f32 v200, v232, v233
v_cvt_pk_bf16_f32 v204, v234, v235
v_pk_fma_f32 v[228:229], v[228:229], v[222:223], v[236:237] op_sel:[1,1,0] op_sel_hi:[0,1,1] neg_lo:[0,1,0]
v_pk_fma_f32 v[230:231], v[230:231], v[222:223], v[238:239] op_sel:[1,1,0] op_sel_hi:[0,1,1] neg_lo:[0,1,0]
v_dot2_f32_bf16 v232, v201, s10, v228
v_dot2_f32_bf16 v233, v201, s11, v230
v_dot2_f32_bf16 v234, v205, s10, v229
v_dot2_f32_bf16 v235, v205, s11, v231
v_pk_mul_f32 v[236:237], v[228:229], v[222:223] op_sel_hi:[1,0]
v_pk_mul_f32 v[238:239], v[230:231], v[222:223] op_sel_hi:[1,0]
v_cvt_pk_bf16_f32 v201, v232, v233
v_cvt_pk_bf16_f32 v205, v234, v235
v_pk_fma_f32 v[228:229], v[228:229], v[222:223], v[236:237] op_sel:[1,1,0] op_sel_hi:[0,1,1] neg_lo:[0,1,0]
v_pk_fma_f32 v[230:231], v[230:231], v[222:223], v[238:239] op_sel:[1,1,0] op_sel_hi:[0,1,1] neg_lo:[0,1,0]
v_dot2_f32_bf16 v232, v202, s10, v228
v_dot2_f32_bf16 v233, v202, s11, v230
v_dot2_f32_bf16 v234, v206, s10, v229
v_dot2_f32_bf16 v235, v206, s11, v231
v_pk_mul_f32 v[236:237], v[228:229], v[222:223] op_sel_hi:[1,0]
v_pk_mul_f32 v[238:239], v[230:231], v[222:223] op_sel_hi:[1,0]
v_cvt_pk_bf16_f32 v202, v232, v233
v_cvt_pk_bf16_f32 v206, v234, v235
v_pk_fma_f32 v[228:229], v[228:229], v[222:223], v[236:237] op_sel:[1,1,0] op_sel_hi:[0,1,1] neg_lo:[0,1,0]
v_pk_fma_f32 v[230:231], v[230:231], v[222:223], v[238:239] op_sel:[1,1,0] op_sel_hi:[0,1,1] neg_lo:[0,1,0]
v_dot2_f32_bf16 v232, v203, s10, v228
v_dot2_f32_bf16 v233, v203, s11, v230
v_dot2_f32_bf16 v234, v207, s10, v229
v_dot2_f32_bf16 v235, v207, s11, v231
v_pk_mul_f32 v[236:237], v[228:229], v[222:223] op_sel_hi:[1,0]
v_pk_mul_f32 v[238:239], v[230:231], v[222:223] op_sel_hi:[1,0]
v_cvt_pk_bf16_f32 v203, v232, v233
v_cvt_pk_bf16_f32 v207, v234, v235
v_pk_fma_f32 v[228:229], v[228:229], v[222:223], v[236:237] op_sel:[1,1,0] op_sel_hi:[0,1,1] neg_lo:[0,1,0]
v_pk_fma_f32 v[230:231], v[230:231], v[222:223], v[238:239] op_sel:[1,1,0] op_sel_hi:[0,1,1] neg_lo:[0,1,0]
ds_write_b128 v7, v[200:203] offset:12880
ds_write_b128 v7, v[204:207] offset:15456
v_dot2_f32_bf16 v232, v208, s10, v228
v_dot2_f32_bf16 v233, v208, s11, v230
v_dot2_f32_bf16 v234, v212, s10, v229
v_dot2_f32_bf16 v235, v212, s11, v231
v_pk_mul_f32 v[236:237], v[228:229], v[222:223] op_sel_hi:[1,0]
v_pk_mul_f32 v[238:239], v[230:231], v[222:223] op_sel_hi:[1,0]
v_cvt_pk_bf16_f32 v208, v232, v233
v_cvt_pk_bf16_f32 v212, v234, v235
v_pk_fma_f32 v[228:229], v[228:229], v[222:223], v[236:237] op_sel:[1,1,0] op_sel_hi:[0,1,1] neg_lo:[0,1,0]
v_pk_fma_f32 v[230:231], v[230:231], v[222:223], v[238:239] op_sel:[1,1,0] op_sel_hi:[0,1,1] neg_lo:[0,1,0]
v_dot2_f32_bf16 v232, v209, s10, v228
v_dot2_f32_bf16 v233, v209, s11, v230
v_dot2_f32_bf16 v234, v213, s10, v229
v_dot2_f32_bf16 v235, v213, s11, v231
v_pk_mul_f32 v[236:237], v[228:229], v[222:223] op_sel_hi:[1,0]
v_pk_mul_f32 v[238:239], v[230:231], v[222:223] op_sel_hi:[1,0]
v_cvt_pk_bf16_f32 v209, v232, v233
v_cvt_pk_bf16_f32 v213, v234, v235
v_pk_fma_f32 v[228:229], v[228:229], v[222:223], v[236:237] op_sel:[1,1,0] op_sel_hi:[0,1,1] neg_lo:[0,1,0]
v_pk_fma_f32 v[230:231], v[230:231], v[222:223], v[238:239] op_sel:[1,1,0] op_sel_hi:[0,1,1] neg_lo:[0,1,0]
v_dot2_f32_bf16 v232, v210, s10, v228
v_dot2_f32_bf16 v233, v210, s11, v230
v_dot2_f32_bf16 v234, v214, s10, v229
v_dot2_f32_bf16 v235, v214, s11, v231
v_pk_mul_f32 v[236:237], v[228:229], v[222:223] op_sel_hi:[1,0]
v_pk_mul_f32 v[238:239], v[230:231], v[222:223] op_sel_hi:[1,0]
v_cvt_pk_bf16_f32 v210, v232, v233
v_cvt_pk_bf16_f32 v214, v234, v235
v_pk_fma_f32 v[228:229], v[228:229], v[222:223], v[236:237] op_sel:[1,1,0] op_sel_hi:[0,1,1] neg_lo:[0,1,0]
v_pk_fma_f32 v[230:231], v[230:231], v[222:223], v[238:239] op_sel:[1,1,0] op_sel_hi:[0,1,1] neg_lo:[0,1,0]
v_dot2_f32_bf16 v232, v211, s10, v228
v_dot2_f32_bf16 v233, v211, s11, v230
v_dot2_f32_bf16 v234, v215, s10, v229
v_dot2_f32_bf16 v235, v215, s11, v231
s_nop 0
v_cvt_pk_bf16_f32 v211, v232, v233
s_nop 0
v_cvt_pk_bf16_f32 v215, v234, v235
ds_write_b128 v7, v[208:211] offset:13904
ds_write_b128 v7, v[212:215] offset:16480
s_waitcnt lgkmcnt(0)
ds_read_b64_tr_b16 v[216:217], v14 offset:0
ds_read_b64_tr_b16 v[218:219], v14 offset:64
ds_read_b64_tr_b16 v[220:221], v14 offset:512
ds_read_b64_tr_b16 v[222:223], v14 offset:576
ds_read_b64_tr_b16 v[224:225], v14 offset:2576
ds_read_b64_tr_b16 v[226:227], v14 offset:2640
ds_read_b64_tr_b16 v[228:229], v14 offset:3088
ds_read_b64_tr_b16 v[230:231], v14 offset:3152
s_add_u32 s71, s70, 36864
s_waitcnt lgkmcnt(6)
buffer_store_dwordx4 v[216:219], v15, s[60:63], s70 offen offset:0 sc1
s_waitcnt lgkmcnt(4)
buffer_store_dwordx4 v[220:223], v15, s[60:63], s70 offen offset:2048 sc1
s_waitcnt lgkmcnt(2)
buffer_store_dwordx4 v[224:227], v15, s[60:63], s71 offen offset:0 sc1
s_waitcnt lgkmcnt(0)
buffer_store_dwordx4 v[228:231], v15, s[60:63], s71 offen offset:2048 sc1
s_add_u32 s7, s13, 4096
buffer_load_dwordx4 v[40:43], v5, s[56:59], s7 offen offset:0
s_add_u32 s7, s14, 4096
buffer_load_dwordx4 v[80:83], v6, s[56:59], s7 offen offset:2048
buffer_load_dwordx4 v[84:87], v6, s[56:59], s7 offen offset:3072
s_add_u32 s7, s13, 4096
buffer_load_dwordx4 v[44:47], v5, s[56:59], s7 offen offset:1024
s_add_u32 s7, s14, 8192
buffer_load_dwordx4 v[88:91], v6, s[56:59], s7 offen offset:0
buffer_load_dwordx4 v[92:95], v6, s[56:59], s7 offen offset:1024
s_add_u32 s7, s13, 4096
buffer_load_dwordx4 v[48:51], v5, s[56:59], s7 offen offset:2048
s_add_u32 s7, s14, 8192
buffer_load_dwordx4 v[96:99], v6, s[56:59], s7 offen offset:2048
buffer_load_dwordx4 v[100:103], v6, s[56:59], s7 offen offset:3072
s_add_u32 s7, s13, 4096
buffer_load_dwordx4 v[52:55], v5, s[56:59], s7 offen offset:3072
s_add_u32 s7, s14, 12288
buffer_load_dwordx4 v[104:107], v6, s[56:59], s7 offen offset:0
buffer_load_dwordx4 v[108:111], v6, s[56:59], s7 offen offset:1024
s_add_u32 s7, s14, 12288
buffer_load_dwordx4 v[112:115], v6, s[56:59], s7 offen offset:2048
buffer_load_dwordx4 v[116:119], v6, s[56:59], s7 offen offset:3072
s_and_b32 s9, s69, 7
s_mul_i32 s9, s9, 144
s_add_u32 s9, s9, s8
buffer_load_dwordx4 v[192:195], v2, s[52:55], s9 offen
buffer_load_dword v196, v3, s[52:55], s9 offen
buffer_load_dword v198, v4, s[52:55], s9 offen
s_and_b32 s9, s69, 7
s_mul_i32 s9, s9, 144
s_add_u32 s9, s9, s8
s_waitcnt vmcnt(30)
v_mfma_f32_32x32x8_bf16 v[120:135], v[16:17], v[188:189], 0
v_mfma_f32_32x32x16_bf16 v[120:135], v[24:27], v[184:187], v[120:135]
s_nop 11
v_exp_f32 v120, v120
v_exp_f32 v121, v121
v_exp_f32 v122, v122
v_exp_f32 v123, v123
v_exp_f32 v124, v124
v_exp_f32 v125, v125
v_mfma_f32_32x32x8_bf16 v[136:151], v[16:17], v[190:191], 0
v_exp_f32 v126, v126
v_exp_f32 v127, v127
v_cvt_pk_bf16_f32 v120, v120, v121
v_cvt_pk_bf16_f32 v121, v122, v123
v_cvt_pk_bf16_f32 v122, v124, v125
v_cvt_pk_bf16_f32 v123, v126, v127
s_waitcnt vmcnt(29)
v_mfma_f32_32x32x16_bf16 v[136:151], v[28:31], v[184:187], v[136:151]
v_exp_f32 v128, v128
v_exp_f32 v129, v129
v_exp_f32 v130, v130
v_exp_f32 v131, v131
v_exp_f32 v132, v132
v_exp_f32 v133, v133
s_waitcnt vmcnt(27)
v_mfma_f32_32x32x16_bf16 v[152:167], v[56:59], v[120:123], v[152:167]
v_exp_f32 v134, v134
v_exp_f32 v135, v135
v_cvt_pk_bf16_f32 v124, v128, v129
v_cvt_pk_bf16_f32 v125, v130, v131
v_cvt_pk_bf16_f32 v126, v132, v133
v_cvt_pk_bf16_f32 v127, v134, v135
v_exp_f32 v136, v136
v_exp_f32 v137, v137
v_mfma_f32_32x32x16_bf16 v[152:167], v[60:63], v[124:127], v[152:167]
v_exp_f32 v138, v138
v_exp_f32 v139, v139
v_exp_f32 v140, v140
v_exp_f32 v141, v141
v_mfma_f32_32x32x8_bf16 v[120:135], v[18:19], v[188:189], 0
v_exp_f32 v142, v142
v_exp_f32 v143, v143
v_cvt_pk_bf16_f32 v136, v136, v137
v_cvt_pk_bf16_f32 v137, v138, v139
v_cvt_pk_bf16_f32 v138, v140, v141
v_cvt_pk_bf16_f32 v139, v142, v143
s_waitcnt vmcnt(26)
v_mfma_f32_32x32x16_bf16 v[120:135], v[32:35], v[184:187], v[120:135]
v_exp_f32 v144, v144
v_exp_f32 v145, v145
v_exp_f32 v146, v146
v_exp_f32 v147, v147
v_exp_f32 v148, v148
v_exp_f32 v149, v149
s_waitcnt vmcnt(24)
v_mfma_f32_32x32x16_bf16 v[152:167], v[64:67], v[136:139], v[152:167]
v_exp_f32 v150, v150
v_exp_f32 v151, v151
v_cvt_pk_bf16_f32 v140, v144, v145
v_cvt_pk_bf16_f32 v141, v146, v147
v_cvt_pk_bf16_f32 v142, v148, v149
v_cvt_pk_bf16_f32 v143, v150, v151
v_exp_f32 v120, v120
v_exp_f32 v121, v121
v_mfma_f32_32x32x16_bf16 v[152:167], v[68:71], v[140:143], v[152:167]
v_exp_f32 v122, v122
v_exp_f32 v123, v123
v_exp_f32 v124, v124
v_exp_f32 v125, v125
v_mfma_f32_32x32x8_bf16 v[136:151], v[18:19], v[190:191], 0
v_exp_f32 v126, v126
v_exp_f32 v127, v127
v_cvt_pk_bf16_f32 v120, v120, v121
v_cvt_pk_bf16_f32 v121, v122, v123
v_cvt_pk_bf16_f32 v122, v124, v125
v_cvt_pk_bf16_f32 v123, v126, v127
s_waitcnt vmcnt(23)
v_mfma_f32_32x32x16_bf16 v[136:151], v[36:39], v[184:187], v[136:151]
v_exp_f32 v128, v128
v_exp_f32 v129, v129
v_exp_f32 v130, v130
v_exp_f32 v131, v131
v_exp_f32 v132, v132
v_exp_f32 v133, v133
s_waitcnt vmcnt(21)
v_mfma_f32_32x32x16_bf16 v[152:167], v[72:75], v[120:123], v[152:167]
v_exp_f32 v134, v134
v_exp_f32 v135, v135
v_cvt_pk_bf16_f32 v124, v128, v129
v_cvt_pk_bf16_f32 v125, v130, v131
v_cvt_pk_bf16_f32 v126, v132, v133
v_cvt_pk_bf16_f32 v127, v134, v135
v_exp_f32 v136, v136
v_exp_f32 v137, v137
v_mfma_f32_32x32x16_bf16 v[152:167], v[76:79], v[124:127], v[152:167]
v_exp_f32 v138, v138
v_exp_f32 v139, v139
v_exp_f32 v140, v140
v_exp_f32 v141, v141
v_mfma_f32_32x32x8_bf16 v[120:135], v[20:21], v[188:189], 0
v_exp_f32 v142, v142
v_exp_f32 v143, v143
v_cvt_pk_bf16_f32 v136, v136, v137
v_cvt_pk_bf16_f32 v137, v138, v139
v_cvt_pk_bf16_f32 v138, v140, v141
v_cvt_pk_bf16_f32 v139, v142, v143
s_waitcnt vmcnt(16)
v_mfma_f32_32x32x16_bf16 v[120:135], v[40:43], v[184:187], v[120:135]
v_exp_f32 v144, v144
v_exp_f32 v145, v145
s_lshr_b32 s7, s2, 2
s_lshl_b32 s7, s7, 5
s_add_u32 s7, s7, s5
s_lshl_b32 s7, s7, 2
s_add_u32 s7, s7, 11177984
s_mov_b64 exec, 1
buffer_store_dword v11, v5, s[60:63], s7 offen sc1
s_mov_b64 exec, -1
v_exp_f32 v146, v146
v_exp_f32 v147, v147
v_exp_f32 v148, v148
v_exp_f32 v149, v149
s_waitcnt vmcnt(15)
v_mfma_f32_32x32x16_bf16 v[152:167], v[80:83], v[136:139], v[152:167]
v_exp_f32 v150, v150
v_exp_f32 v151, v151
v_cvt_pk_bf16_f32 v140, v144, v145
v_cvt_pk_bf16_f32 v141, v146, v147
v_cvt_pk_bf16_f32 v142, v148, v149
v_cvt_pk_bf16_f32 v143, v150, v151
v_exp_f32 v120, v120
v_exp_f32 v121, v121
v_mfma_f32_32x32x16_bf16 v[152:167], v[84:87], v[140:143], v[152:167]
v_exp_f32 v122, v122
v_exp_f32 v123, v123
v_exp_f32 v124, v124
v_exp_f32 v125, v125
v_mfma_f32_32x32x8_bf16 v[136:151], v[20:21], v[190:191], 0
v_exp_f32 v126, v126
v_exp_f32 v127, v127
v_cvt_pk_bf16_f32 v120, v120, v121
v_cvt_pk_bf16_f32 v121, v122, v123
v_cvt_pk_bf16_f32 v122, v124, v125
v_cvt_pk_bf16_f32 v123, v126, v127
s_waitcnt vmcnt(14)
v_mfma_f32_32x32x16_bf16 v[136:151], v[44:47], v[184:187], v[136:151]
v_exp_f32 v128, v128
v_exp_f32 v129, v129
v_exp_f32 v130, v130
v_exp_f32 v131, v131
v_exp_f32 v132, v132
v_exp_f32 v133, v133
s_waitcnt vmcnt(12)
v_mfma_f32_32x32x16_bf16 v[152:167], v[88:91], v[120:123], v[152:167]
v_exp_f32 v134, v134
v_exp_f32 v135, v135
v_cvt_pk_bf16_f32 v124, v128, v129
v_cvt_pk_bf16_f32 v125, v130, v131
v_cvt_pk_bf16_f32 v126, v132, v133
v_cvt_pk_bf16_f32 v127, v134, v135
v_exp_f32 v136, v136
v_exp_f32 v137, v137
v_mfma_f32_32x32x16_bf16 v[152:167], v[92:95], v[124:127], v[152:167]
v_exp_f32 v138, v138
v_exp_f32 v139, v139
v_exp_f32 v140, v140
v_exp_f32 v141, v141
v_mfma_f32_32x32x8_bf16 v[120:135], v[22:23], v[188:189], 0
v_exp_f32 v142, v142
v_exp_f32 v143, v143
v_cvt_pk_bf16_f32 v136, v136, v137
v_cvt_pk_bf16_f32 v137, v138, v139
v_cvt_pk_bf16_f32 v138, v140, v141
v_cvt_pk_bf16_f32 v139, v142, v143
s_waitcnt vmcnt(11)
v_mfma_f32_32x32x16_bf16 v[120:135], v[48:51], v[184:187], v[120:135]
v_exp_f32 v144, v144
v_exp_f32 v145, v145
v_exp_f32 v146, v146
v_exp_f32 v147, v147
v_exp_f32 v148, v148
v_exp_f32 v149, v149
s_waitcnt vmcnt(9)
v_mfma_f32_32x32x16_bf16 v[152:167], v[96:99], v[136:139], v[152:167]
v_exp_f32 v150, v150
v_exp_f32 v151, v151
v_cvt_pk_bf16_f32 v140, v144, v145
v_cvt_pk_bf16_f32 v141, v146, v147
v_cvt_pk_bf16_f32 v142, v148, v149
v_cvt_pk_bf16_f32 v143, v150, v151
v_exp_f32 v120, v120
v_exp_f32 v121, v121
v_mfma_f32_32x32x16_bf16 v[152:167], v[100:103], v[140:143], v[152:167]
v_exp_f32 v122, v122
v_exp_f32 v123, v123
v_exp_f32 v124, v124
v_exp_f32 v125, v125
v_mfma_f32_32x32x8_bf16 v[136:151], v[22:23], v[190:191], 0
v_exp_f32 v126, v126
v_exp_f32 v127, v127
v_cvt_pk_bf16_f32 v120, v120, v121
v_cvt_pk_bf16_f32 v121, v122, v123
v_cvt_pk_bf16_f32 v122, v124, v125
v_cvt_pk_bf16_f32 v123, v126, v127
s_waitcnt vmcnt(8)
v_mfma_f32_32x32x16_bf16 v[136:151], v[52:55], v[184:187], v[136:151]
v_exp_f32 v128, v128
v_exp_f32 v129, v129
v_exp_f32 v130, v130
v_exp_f32 v131, v131
v_exp_f32 v132, v132
v_exp_f32 v133, v133
s_waitcnt vmcnt(6)
v_mfma_f32_32x32x16_bf16 v[152:167], v[104:107], v[120:123], v[152:167]
v_exp_f32 v134, v134
v_exp_f32 v135, v135
v_cvt_pk_bf16_f32 v124, v128, v129
v_cvt_pk_bf16_f32 v125, v130, v131
v_cvt_pk_bf16_f32 v126, v132, v133
v_cvt_pk_bf16_f32 v127, v134, v135
v_exp_f32 v136, v136
v_exp_f32 v137, v137
v_mfma_f32_32x32x16_bf16 v[152:167], v[108:111], v[124:127], v[152:167]
v_exp_f32 v138, v138
v_exp_f32 v139, v139
v_exp_f32 v140, v140
v_exp_f32 v141, v141
s_waitcnt vmcnt(1)
v_mfma_f32_32x32x8_bf16 v[120:135], v[16:17], v[196:197], 0
v_exp_f32 v142, v142
v_exp_f32 v143, v143
v_cvt_pk_bf16_f32 v136, v136, v137
v_cvt_pk_bf16_f32 v137, v138, v139
v_cvt_pk_bf16_f32 v138, v140, v141
v_cvt_pk_bf16_f32 v139, v142, v143
v_mfma_f32_32x32x16_bf16 v[120:135], v[24:27], v[192:195], v[120:135]
v_exp_f32 v144, v144
v_exp_f32 v145, v145
v_exp_f32 v146, v146
v_exp_f32 v147, v147
v_exp_f32 v148, v148
v_exp_f32 v149, v149
v_mfma_f32_32x32x16_bf16 v[152:167], v[112:115], v[136:139], v[152:167]
v_exp_f32 v150, v150
v_exp_f32 v151, v151
v_cvt_pk_bf16_f32 v140, v144, v145
v_cvt_pk_bf16_f32 v141, v146, v147
v_cvt_pk_bf16_f32 v142, v148, v149
v_cvt_pk_bf16_f32 v143, v150, v151
s_branch k2_r1
k2_nofx2:
s_and_b32 s9, s69, 7
s_mul_i32 s9, s9, 144
s_add_u32 s9, s9, s8
s_waitcnt vmcnt(6)
v_mfma_f32_32x32x8_bf16 v[120:135], v[16:17], v[188:189], 0
v_mfma_f32_32x32x16_bf16 v[120:135], v[24:27], v[184:187], v[120:135]
s_nop 11
v_exp_f32 v120, v120
v_exp_f32 v121, v121
v_exp_f32 v122, v122
v_exp_f32 v123, v123
v_exp_f32 v124, v124
v_exp_f32 v125, v125
v_mfma_f32_32x32x8_bf16 v[136:151], v[16:17], v[190:191], 0
v_exp_f32 v126, v126
v_exp_f32 v127, v127
v_cvt_pk_bf16_f32 v120, v120, v121
v_cvt_pk_bf16_f32 v121, v122, v123
v_cvt_pk_bf16_f32 v122, v124, v125
v_cvt_pk_bf16_f32 v123, v126, v127
s_waitcnt vmcnt(5)
v_mfma_f32_32x32x16_bf16 v[136:151], v[28:31], v[184:187], v[136:151]
v_exp_f32 v128, v128
v_exp_f32 v129, v129
s_add_u32 s7, s13, 0
buffer_load_dwordx4 v[36:39], v5, s[56:59], s7 offen offset:3072
s_add_u32 s7, s14, 4096
buffer_load_dwordx4 v[72:75], v6, s[56:59], s7 offen offset:0
buffer_load_dwordx4 v[76:79], v6, s[56:59], s7 offen offset:1024
v_exp_f32 v130, v130
v_exp_f32 v131, v131
v_exp_f32 v132, v132
v_exp_f32 v133, v133
s_waitcnt vmcnt(6)
v_mfma_f32_32x32x16_bf16 v[152:167], v[56:59], v[120:123], v[152:167]
v_exp_f32 v134, v134
v_exp_f32 v135, v135
v_cvt_pk_bf16_f32 v124, v128, v129
v_cvt_pk_bf16_f32 v125, v130, v131
v_cvt_pk_bf16_f32 v126, v132, v133
v_cvt_pk_bf16_f32 v127, v134, v135
v_exp_f32 v136, v136
v_exp_f32 v137, v137
v_mfma_f32_32x32x16_bf16 v[152:167], v[60:63], v[124:127], v[152:167]
v_exp_f32 v138, v138
v_exp_f32 v139, v139
v_exp_f32 v140, v140
v_exp_f32 v141, v141
v_mfma_f32_32x32x8_bf16 v[120:135], v[18:19], v[188:189], 0
v_exp_f32 v142, v142
v_exp_f32 v143, v143
v_cvt_pk_bf16_f32 v136, v136, v137
v_cvt_pk_bf16_f32 v137, v138, v139
v_cvt_pk_bf16_f32 v138, v140, v141
v_cvt_pk_bf16_f32 v139, v142, v143
s_waitcnt vmcnt(5)
v_mfma_f32_32x32x16_bf16 v[120:135], v[32:35], v[184:187], v[120:135]
v_exp_f32 v144, v144
v_exp_f32 v145, v145
s_add_u32 s7, s13, 4096
buffer_load_dwordx4 v[40:43], v5, s[56:59], s7 offen offset:0
s_add_u32 s7, s14, 4096
buffer_load_dwordx4 v[80:83], v6, s[56:59], s7 offen offset:2048
buffer_load_dwordx4 v[84:87], v6, s[56:59], s7 offen offset:3072
v_exp_f32 v146, v146
v_exp_f32 v147, v147
v_exp_f32 v148, v148
v_exp_f32 v149, v149
s_waitcnt vmcnt(6)
v_mfma_f32_32x32x16_bf16 v[152:167], v[64:67], v[136:139], v[152:167]
v_exp_f32 v150, v150
v_exp_f32 v151, v151
v_cvt_pk_bf16_f32 v140, v144, v145
v_cvt_pk_bf16_f32 v141, v146, v147
v_cvt_pk_bf16_f32 v142, v148, v149
v_cvt_pk_bf16_f32 v143, v150, v151
v_exp_f32 v120, v120
v_exp_f32 v121, v121
v_mfma_f32_32x32x16_bf16 v[152:167], v[68:71], v[140:143], v[152:167]
v_exp_f32 v122, v122
v_exp_f32 v123, v123
v_exp_f32 v124, v124
v_exp_f32 v125, v125
v_mfma_f32_32x32x8_bf16 v[136:151], v[18:19], v[190:191], 0
v_exp_f32 v126, v126
v_exp_f32 v127, v127
v_cvt_pk_bf16_f32 v120, v120, v121
v_cvt_pk_bf16_f32 v121, v122, v123
v_cvt_pk_bf16_f32 v122, v124, v125
v_cvt_pk_bf16_f32 v123, v126, v127
s_waitcnt vmcnt(5)
v_mfma_f32_32x32x16_bf16 v[136:151], v[36:39], v[184:187], v[136:151]
v_exp_f32 v128, v128
v_exp_f32 v129, v129
s_add_u32 s7, s13, 4096
buffer_load_dwordx4 v[44:47], v5, s[56:59], s7 offen offset:1024
s_add_u32 s7, s14, 8192
buffer_load_dwordx4 v[88:91], v6, s[56:59], s7 offen offset:0
buffer_load_dwordx4 v[92:95], v6, s[56:59], s7 offen offset:1024
v_exp_f32 v130, v130
v_exp_f32 v131, v131
v_exp_f32 v132, v132
v_exp_f32 v133, v133
s_waitcnt vmcnt(6)
v_mfma_f32_32x32x16_bf16 v[152:167], v[72:75], v[120:123], v[152:167]
v_exp_f32 v134, v134
v_exp_f32 v135, v135
v_cvt_pk_bf16_f32 v124, v128, v129
v_cvt_pk_bf16_f32 v125, v130, v131
v_cvt_pk_bf16_f32 v126, v132, v133
v_cvt_pk_bf16_f32 v127, v134, v135
v_exp_f32 v136, v136
v_exp_f32 v137, v137
v_mfma_f32_32x32x16_bf16 v[152:167], v[76:79], v[124:127], v[152:167]
v_exp_f32 v138, v138
v_exp_f32 v139, v139
v_exp_f32 v140, v140
v_exp_f32 v141, v141
v_mfma_f32_32x32x8_bf16 v[120:135], v[20:21], v[188:189], 0
v_exp_f32 v142, v142
v_exp_f32 v143, v143
v_cvt_pk_bf16_f32 v136, v136, v137
v_cvt_pk_bf16_f32 v137, v138, v139
v_cvt_pk_bf16_f32 v138, v140, v141
v_cvt_pk_bf16_f32 v139, v142, v143
s_waitcnt vmcnt(5)
v_mfma_f32_32x32x16_bf16 v[120:135], v[40:43], v[184:187], v[120:135]
v_exp_f32 v144, v144
v_exp_f32 v145, v145
s_add_u32 s7, s13, 4096
buffer_load_dwordx4 v[48:51], v5, s[56:59], s7 offen offset:2048
s_add_u32 s7, s14, 8192
buffer_load_dwordx4 v[96:99], v6, s[56:59], s7 offen offset:2048
buffer_load_dwordx4 v[100:103], v6, s[56:59], s7 offen offset:3072
v_exp_f32 v146, v146
v_exp_f32 v147, v147
v_exp_f32 v148, v148
v_exp_f32 v149, v149
s_waitcnt vmcnt(6)
v_mfma_f32_32x32x16_bf16 v[152:167], v[80:83], v[136:139], v[152:167]
v_exp_f32 v150, v150
v_exp_f32 v151, v151
v_cvt_pk_bf16_f32 v140, v144, v145
v_cvt_pk_bf16_f32 v141, v146, v147
v_cvt_pk_bf16_f32 v142, v148, v149
v_cvt_pk_bf16_f32 v143, v150, v151
v_exp_f32 v120, v120
v_exp_f32 v121, v121
v_mfma_f32_32x32x16_bf16 v[152:167], v[84:87], v[140:143], v[152:167]
v_exp_f32 v122, v122
v_exp_f32 v123, v123
v_exp_f32 v124, v124
v_exp_f32 v125, v125
v_mfma_f32_32x32x8_bf16 v[136:151], v[20:21], v[190:191], 0
v_exp_f32 v126, v126
v_exp_f32 v127, v127
v_cvt_pk_bf16_f32 v120, v120, v121
v_cvt_pk_bf16_f32 v121, v122, v123
v_cvt_pk_bf16_f32 v122, v124, v125
v_cvt_pk_bf16_f32 v123, v126, v127
s_waitcnt vmcnt(5)
v_mfma_f32_32x32x16_bf16 v[136:151], v[44:47], v[184:187], v[136:151]
v_exp_f32 v128, v128
v_exp_f32 v129, v129
s_add_u32 s7, s13, 4096
buffer_load_dwordx4 v[52:55], v5, s[56:59], s7 offen offset:3072
s_add_u32 s7, s14, 12288
buffer_load_dwordx4 v[104:107], v6, s[56:59], s7 offen offset:0
buffer_load_dwordx4 v[108:111], v6, s[56:59], s7 offen offset:1024
v_exp_f32 v130, v130
v_exp_f32 v131, v131
v_exp_f32 v132, v132
v_exp_f32 v133, v133
s_waitcnt vmcnt(6)
v_mfma_f32_32x32x16_bf16 v[152:167], v[88:91], v[120:123], v[152:167]
v_exp_f32 v134, v134
v_exp_f32 v135, v135
v_cvt_pk_bf16_f32 v124, v128, v129
v_cvt_pk_bf16_f32 v125, v130, v131
v_cvt_pk_bf16_f32 v126, v132, v133
v_cvt_pk_bf16_f32 v127, v134, v135
v_exp_f32 v136, v136
v_exp_f32 v137, v137
v_mfma_f32_32x32x16_bf16 v[152:167], v[92:95], v[124:127], v[152:167]
v_exp_f32 v138, v138
v_exp_f32 v139, v139
v_exp_f32 v140, v140
v_exp_f32 v141, v141
v_mfma_f32_32x32x8_bf16 v[120:135], v[22:23], v[188:189], 0
v_exp_f32 v142, v142
v_exp_f32 v143, v143
v_cvt_pk_bf16_f32 v136, v136, v137
v_cvt_pk_bf16_f32 v137, v138, v139
v_cvt_pk_bf16_f32 v138, v140, v141
v_cvt_pk_bf16_f32 v139, v142, v143
s_waitcnt vmcnt(5)
v_mfma_f32_32x32x16_bf16 v[120:135], v[48:51], v[184:187], v[120:135]
v_exp_f32 v144, v144
v_exp_f32 v145, v145
s_add_u32 s7, s14, 12288
buffer_load_dwordx4 v[112:115], v6, s[56:59], s7 offen offset:2048
buffer_load_dwordx4 v[116:119], v6, s[56:59], s7 offen offset:3072
buffer_load_dwordx4 v[192:195], v2, s[52:55], s9 offen
buffer_load_dword v196, v3, s[52:55], s9 offen
buffer_load_dword v198, v4, s[52:55], s9 offen
v_exp_f32 v146, v146
v_exp_f32 v147, v147
v_exp_f32 v148, v148
v_exp_f32 v149, v149
s_waitcnt vmcnt(8)
v_mfma_f32_32x32x16_bf16 v[152:167], v[96:99], v[136:139], v[152:167]
v_exp_f32 v150, v150
v_exp_f32 v151, v151
v_cvt_pk_bf16_f32 v140, v144, v145
v_cvt_pk_bf16_f32 v141, v146, v147
v_cvt_pk_bf16_f32 v142, v148, v149
v_cvt_pk_bf16_f32 v143, v150, v151
v_exp_f32 v120, v120
v_exp_f32 v121, v121
v_mfma_f32_32x32x16_bf16 v[152:167], v[100:103], v[140:143], v[152:167]
v_exp_f32 v122, v122
v_exp_f32 v123, v123
v_exp_f32 v124, v124
v_exp_f32 v125, v125
v_mfma_f32_32x32x8_bf16 v[136:151], v[22:23], v[190:191], 0
v_exp_f32 v126, v126
v_exp_f32 v127, v127
v_cvt_pk_bf16_f32 v120, v120, v121
v_cvt_pk_bf16_f32 v121, v122, v123
v_cvt_pk_bf16_f32 v122, v124, v125
v_cvt_pk_bf16_f32 v123, v126, v127
s_waitcnt vmcnt(7)
v_mfma_f32_32x32x16_bf16 v[136:151], v[52:55], v[184:187], v[136:151]
v_exp_f32 v128, v128
v_exp_f32 v129, v129
v_exp_f32 v130, v130
v_exp_f32 v131, v131
v_exp_f32 v132, v132
v_exp_f32 v133, v133
s_waitcnt vmcnt(5)
v_mfma_f32_32x32x16_bf16 v[152:167], v[104:107], v[120:123], v[152:167]
v_exp_f32 v134, v134
v_exp_f32 v135, v135
v_cvt_pk_bf16_f32 v124, v128, v129
v_cvt_pk_bf16_f32 v125, v130, v131
v_cvt_pk_bf16_f32 v126, v132, v133
v_cvt_pk_bf16_f32 v127, v134, v135
v_exp_f32 v136, v136
v_exp_f32 v137, v137
v_mfma_f32_32x32x16_bf16 v[152:167], v[108:111], v[124:127], v[152:167]
v_exp_f32 v138, v138
v_exp_f32 v139, v139
v_exp_f32 v140, v140
v_exp_f32 v141, v141
s_waitcnt vmcnt(0)
v_mfma_f32_32x32x8_bf16 v[120:135], v[16:17], v[196:197], 0
v_exp_f32 v142, v142
v_exp_f32 v143, v143
v_cvt_pk_bf16_f32 v136, v136, v137
v_cvt_pk_bf16_f32 v137, v138, v139
v_cvt_pk_bf16_f32 v138, v140, v141
v_cvt_pk_bf16_f32 v139, v142, v143
v_mfma_f32_32x32x16_bf16 v[120:135], v[24:27], v[192:195], v[120:135]
v_exp_f32 v144, v144
v_exp_f32 v145, v145
v_exp_f32 v146, v146
v_exp_f32 v147, v147
v_exp_f32 v148, v148
v_exp_f32 v149, v149
v_mfma_f32_32x32x16_bf16 v[152:167], v[112:115], v[136:139], v[152:167]
v_exp_f32 v150, v150
v_exp_f32 v151, v151
v_cvt_pk_bf16_f32 v140, v144, v145
v_cvt_pk_bf16_f32 v141, v146, v147
v_cvt_pk_bf16_f32 v142, v148, v149
v_cvt_pk_bf16_f32 v143, v150, v151
k2_r1:
v_exp_f32 v120, v120
v_exp_f32 v121, v121
v_mfma_f32_32x32x16_bf16 v[152:167], v[116:119], v[140:143], v[152:167]
v_exp_f32 v122, v122
v_exp_f32 v123, v123
v_exp_f32 v124, v124
v_exp_f32 v125, v125
v_mfma_f32_32x32x8_bf16 v[136:151], v[16:17], v[198:199], 0
v_exp_f32 v126, v126
v_exp_f32 v127, v127
v_cvt_pk_bf16_f32 v120, v120, v121
v_cvt_pk_bf16_f32 v121, v122, v123
v_cvt_pk_bf16_f32 v122, v124, v125
v_cvt_pk_bf16_f32 v123, v126, v127
v_mfma_f32_32x32x16_bf16 v[136:151], v[28:31], v[192:195], v[136:151]
v_exp_f32 v128, v128
v_exp_f32 v129, v129
ds_write_b128 v7, v[152:155] offset:0
ds_write_b128 v7, v[156:159] offset:1024
ds_write_b64 v8, v[160:161] offset:0
s_add_u32 s69, s69, 1
s_and_b32 s9, s69, 7
s_mul_i32 s9, s9, 144
s_add_u32 s9, s9, s8
buffer_load_dwordx4 v[184:187], v2, s[52:55], s9 offen
buffer_load_dword v188, v3, s[52:55], s9 offen
buffer_load_dword v190, v4, s[52:55], s9 offen
v_exp_f32 v130, v130
v_exp_f32 v131, v131
v_exp_f32 v132, v132
v_exp_f32 v133, v133
v_mfma_f32_32x32x16_bf16 v[168:183], v[56:59], v[120:123], v[168:183]
v_exp_f32 v134, v134
v_exp_f32 v135, v135
v_cvt_pk_bf16_f32 v124, v128, v129
v_cvt_pk_bf16_f32 v125, v130, v131
v_cvt_pk_bf16_f32 v126, v132, v133
v_cvt_pk_bf16_f32 v127, v134, v135
v_exp_f32 v136, v136
v_exp_f32 v137, v137
v_mfma_f32_32x32x16_bf16 v[168:183], v[60:63], v[124:127], v[168:183]
v_exp_f32 v138, v138
v_exp_f32 v139, v139
v_exp_f32 v140, v140
v_exp_f32 v141, v141
v_mfma_f32_32x32x8_bf16 v[120:135], v[18:19], v[196:197], 0
v_exp_f32 v142, v142
v_exp_f32 v143, v143
v_cvt_pk_bf16_f32 v136, v136, v137
v_cvt_pk_bf16_f32 v137, v138, v139
v_cvt_pk_bf16_f32 v138, v140, v141
v_cvt_pk_bf16_f32 v139, v142, v143
v_mfma_f32_32x32x16_bf16 v[120:135], v[32:35], v[192:195], v[120:135]
v_exp_f32 v144, v144
v_exp_f32 v145, v145
s_waitcnt lgkmcnt(0)
s_mov_b64 exec, 1
ds_write_b32 v8, v11 offset:512
s_mov_b64 exec, -1
v_exp_f32 v146, v146
v_exp_f32 v147, v147
v_exp_f32 v148, v148
v_exp_f32 v149, v149
v_mfma_f32_32x32x16_bf16 v[168:183], v[64:67], v[136:139], v[168:183]
v_exp_f32 v150, v150
v_exp_f32 v151, v151
v_cvt_pk_bf16_f32 v140, v144, v145
v_cvt_pk_bf16_f32 v141, v146, v147
v_cvt_pk_bf16_f32 v142, v148, v149
v_cvt_pk_bf16_f32 v143, v150, v151
v_exp_f32 v120, v120
v_exp_f32 v121, v121
v_mfma_f32_32x32x16_bf16 v[168:183], v[68:71], v[140:143], v[168:183]
v_exp_f32 v122, v122
v_exp_f32 v123, v123
v_exp_f32 v124, v124
v_exp_f32 v125, v125
v_mfma_f32_32x32x8_bf16 v[136:151], v[18:19], v[198:199], 0
v_exp_f32 v126, v126
v_exp_f32 v127, v127
v_cvt_pk_bf16_f32 v120, v120, v121
v_cvt_pk_bf16_f32 v121, v122, v123
v_cvt_pk_bf16_f32 v122, v124, v125
v_cvt_pk_bf16_f32 v123, v126, v127
v_mfma_f32_32x32x16_bf16 v[136:151], v[36:39], v[192:195], v[136:151]
v_exp_f32 v128, v128
v_exp_f32 v129, v129
s_mov_b32 s92, s16
s_and_b32 s93, s17, 0xffff
s_mov_b32 s94, 2359296
s_mov_b32 s95, 0x20000
s_mov_b32 s96, s32
s_and_b32 s97, s33, 0xffff
s_mov_b32 s98, 1152
s_mov_b32 s99, 0x20000
s_and_b32 s9, s2, 3
s_lshl_b32 s9, s9, 2
s_and_b32 s10, s3, 3
s_add_u32 s9, s9, s10
s_lshl_b32 s9, s9, 6
s_lshr_b32 s10, s3, 2
s_lshl_b32 s10, s10, 5
s_add_u32 s68, s9, s10
s_lshr_b32 s10, s2, 2
s_mul_i32 s10, s10, 36864
s_add_u32 s10, s10, s68
v_lshrrev_b32 v14, 5, v0
v_lshlrev_b32 v14, 3, v14
v_and_b32 v15, 31, v0
v_mul_u32_u24 v15, 1152, v15
v_add_u32 v15, v15, v14
buffer_load_dwordx2 v[240:241], v15, s[92:95], s10 offen offset:0
buffer_load_dwordx2 v[244:245], v14, s[96:99], s68 offen offset:0
buffer_load_dwordx2 v[242:243], v15, s[92:95], s10 offen offset:16
buffer_load_dwordx2 v[246:247], v14, s[96:99], s68 offen offset:16
v_exp_f32 v130, v130
v_exp_f32 v131, v131
v_exp_f32 v132, v132
v_exp_f32 v133, v133
v_mfma_f32_32x32x16_bf16 v[168:183], v[72:75], v[120:123], v[168:183]
v_exp_f32 v134, v134
v_exp_f32 v135, v135
v_cvt_pk_bf16_f32 v124, v128, v129
v_cvt_pk_bf16_f32 v125, v130, v131
v_cvt_pk_bf16_f32 v126, v132, v133
v_cvt_pk_bf16_f32 v127, v134, v135
v_exp_f32 v136, v136
v_exp_f32 v137, v137
v_mfma_f32_32x32x16_bf16 v[168:183], v[76:79], v[124:127], v[168:183]
v_exp_f32 v138, v138
v_exp_f32 v139, v139
v_exp_f32 v140, v140
v_exp_f32 v141, v141
v_mfma_f32_32x32x8_bf16 v[120:135], v[20:21], v[196:197], 0
v_exp_f32 v142, v142
v_exp_f32 v143, v143
v_cvt_pk_bf16_f32 v136, v136, v137
v_cvt_pk_bf16_f32 v137, v138, v139
v_cvt_pk_bf16_f32 v138, v140, v141
v_cvt_pk_bf16_f32 v139, v142, v143
v_mfma_f32_32x32x16_bf16 v[120:135], v[40:43], v[192:195], v[120:135]
v_exp_f32 v144, v144
v_exp_f32 v145, v145
v_exp_f32 v146, v146
v_exp_f32 v147, v147
v_exp_f32 v148, v148
v_exp_f32 v149, v149
v_mfma_f32_32x32x16_bf16 v[168:183], v[80:83], v[136:139], v[168:183]
v_exp_f32 v150, v150
v_exp_f32 v151, v151
v_cvt_pk_bf16_f32 v140, v144, v145
v_cvt_pk_bf16_f32 v141, v146, v147
v_cvt_pk_bf16_f32 v142, v148, v149
v_cvt_pk_bf16_f32 v143, v150, v151
v_exp_f32 v120, v120
v_exp_f32 v121, v121
v_mfma_f32_32x32x16_bf16 v[168:183], v[84:87], v[140:143], v[168:183]
v_exp_f32 v122, v122
v_exp_f32 v123, v123
v_exp_f32 v124, v124
v_exp_f32 v125, v125
v_mfma_f32_32x32x8_bf16 v[136:151], v[20:21], v[198:199], 0
v_exp_f32 v126, v126
v_exp_f32 v127, v127
v_cvt_pk_bf16_f32 v120, v120, v121
v_cvt_pk_bf16_f32 v121, v122, v123
v_cvt_pk_bf16_f32 v122, v124, v125
v_cvt_pk_bf16_f32 v123, v126, v127
v_mfma_f32_32x32x16_bf16 v[136:151], v[44:47], v[192:195], v[136:151]
v_exp_f32 v128, v128
v_exp_f32 v129, v129
ds_read_b32 v12, v10 offset:512
v_exp_f32 v130, v130
v_exp_f32 v131, v131
v_exp_f32 v132, v132
v_exp_f32 v133, v133
v_mfma_f32_32x32x16_bf16 v[168:183], v[88:91], v[120:123], v[168:183]
v_exp_f32 v134, v134
v_exp_f32 v135, v135
v_cvt_pk_bf16_f32 v124, v128, v129
v_cvt_pk_bf16_f32 v125, v130, v131
v_cvt_pk_bf16_f32 v126, v132, v133
v_cvt_pk_bf16_f32 v127, v134, v135
v_exp_f32 v136, v136
v_exp_f32 v137, v137
v_mfma_f32_32x32x16_bf16 v[168:183], v[92:95], v[124:127], v[168:183]
v_exp_f32 v138, v138
v_exp_f32 v139, v139
v_exp_f32 v140, v140
v_exp_f32 v141, v141
v_mfma_f32_32x32x8_bf16 v[120:135], v[22:23], v[196:197], 0
v_exp_f32 v142, v142
v_exp_f32 v143, v143
v_cvt_pk_bf16_f32 v136, v136, v137
v_cvt_pk_bf16_f32 v137, v138, v139
v_cvt_pk_bf16_f32 v138, v140, v141
v_cvt_pk_bf16_f32 v139, v142, v143
v_mfma_f32_32x32x16_bf16 v[120:135], v[48:51], v[192:195], v[120:135]
v_exp_f32 v144, v144
v_exp_f32 v145, v145
k2_pollr1:
s_waitcnt lgkmcnt(0)
v_readfirstlane_b32 s9, v12
s_nop 0
s_cmp_lg_u32 s9, 0
s_cbranch_scc1 k2_okr1
s_sleep 2
ds_read_b32 v12, v10 offset:512
s_branch k2_pollr1
k2_okr1:
ds_read_b128 v[152:155], v9 offset:0
ds_read_b128 v[156:159], v9 offset:1024
ds_read_b64 v[160:161], v10 offset:0
v_exp_f32 v146, v146
v_exp_f32 v147, v147
v_exp_f32 v148, v148
v_exp_f32 v149, v149
v_mfma_f32_32x32x16_bf16 v[168:183], v[96:99], v[136:139], v[168:183]
v_exp_f32 v150, v150
v_exp_f32 v151, v151
v_cvt_pk_bf16_f32 v140, v144, v145
v_cvt_pk_bf16_f32 v141, v146, v147
v_cvt_pk_bf16_f32 v142, v148, v149
v_cvt_pk_bf16_f32 v143, v150, v151
v_exp_f32 v120, v120
v_exp_f32 v121, v121
v_mfma_f32_32x32x16_bf16 v[168:183], v[100:103], v[140:143], v[168:183]
v_exp_f32 v122, v122
v_exp_f32 v123, v123
v_exp_f32 v124, v124
v_exp_f32 v125, v125
v_mfma_f32_32x32x8_bf16 v[136:151], v[22:23], v[198:199], 0
v_exp_f32 v126, v126
v_exp_f32 v127, v127
v_cvt_pk_bf16_f32 v120, v120, v121
v_cvt_pk_bf16_f32 v121, v122, v123
v_cvt_pk_bf16_f32 v122, v124, v125
v_cvt_pk_bf16_f32 v123, v126, v127
v_mfma_f32_32x32x16_bf16 v[136:151], v[52:55], v[192:195], v[136:151]
v_exp_f32 v128, v128
v_exp_f32 v129, v129
v_exp_f32 v130, v130
v_exp_f32 v131, v131
v_exp_f32 v132, v132
v_exp_f32 v133, v133
v_mfma_f32_32x32x16_bf16 v[168:183], v[104:107], v[120:123], v[168:183]
v_exp_f32 v134, v134
v_exp_f32 v135, v135
v_cvt_pk_bf16_f32 v124, v128, v129
v_cvt_pk_bf16_f32 v125, v130, v131
v_cvt_pk_bf16_f32 v126, v132, v133
v_cvt_pk_bf16_f32 v127, v134, v135
v_exp_f32 v136, v136
v_exp_f32 v137, v137
v_mfma_f32_32x32x16_bf16 v[168:183], v[108:111], v[124:127], v[168:183]
v_exp_f32 v138, v138
v_exp_f32 v139, v139
v_exp_f32 v140, v140
v_exp_f32 v141, v141
s_waitcnt vmcnt(4)
v_mfma_f32_32x32x8_bf16 v[120:135], v[16:17], v[188:189], 0
v_exp_f32 v142, v142
v_exp_f32 v143, v143
v_cvt_pk_bf16_f32 v136, v136, v137
v_cvt_pk_bf16_f32 v137, v138, v139
v_cvt_pk_bf16_f32 v138, v140, v141
v_cvt_pk_bf16_f32 v139, v142, v143
v_mfma_f32_32x32x16_bf16 v[120:135], v[24:27], v[184:187], v[120:135]
v_exp_f32 v144, v144
v_exp_f32 v145, v145
v_exp_f32 v146, v146
v_exp_f32 v147, v147
v_exp_f32 v148, v148
v_exp_f32 v149, v149
s_waitcnt lgkmcnt(0)
v_mfma_f32_32x32x16_bf16 v[168:183], v[112:115], v[136:139], v[168:183]
v_exp_f32 v150, v150
v_exp_f32 v151, v151
v_cvt_pk_bf16_f32 v140, v144, v145
v_cvt_pk_bf16_f32 v141, v146, v147
v_cvt_pk_bf16_f32 v142, v148, v149
v_cvt_pk_bf16_f32 v143, v150, v151
v_exp_f32 v120, v120
v_exp_f32 v121, v121
v_mfma_f32_32x32x16_bf16 v[168:183], v[116:119], v[140:143], v[168:183]
v_exp_f32 v122, v122
v_exp_f32 v123, v123
v_exp_f32 v124, v124
v_exp_f32 v125, v125
v_mfma_f32_32x32x8_bf16 v[136:151], v[16:17], v[190:191], 0
v_exp_f32 v126, v126
v_exp_f32 v127, v127
v_cvt_pk_bf16_f32 v120, v120, v121
v_cvt_pk_bf16_f32 v121, v122, v123
v_cvt_pk_bf16_f32 v122, v124, v125
v_cvt_pk_bf16_f32 v123, v126, v127
v_mfma_f32_32x32x16_bf16 v[136:151], v[28:31], v[184:187], v[136:151]
v_exp_f32 v128, v128
v_exp_f32 v129, v129
ds_write_b128 v7, v[168:171] offset:2576
ds_write_b128 v7, v[172:175] offset:3600
ds_write_b64 v8, v[176:177] offset:2576
s_add_u32 s69, s69, 1
s_and_b32 s9, s69, 7
s_mul_i32 s9, s9, 144
s_add_u32 s9, s9, s8
buffer_load_dwordx4 v[192:195], v2, s[52:55], s9 offen
buffer_load_dword v196, v3, s[52:55], s9 offen
buffer_load_dword v198, v4, s[52:55], s9 offen
v_exp_f32 v130, v130
v_exp_f32 v131, v131
v_exp_f32 v132, v132
v_exp_f32 v133, v133
v_mfma_f32_32x32x16_bf16 v[152:167], v[56:59], v[120:123], v[152:167]
v_exp_f32 v134, v134
v_exp_f32 v135, v135
v_cvt_pk_bf16_f32 v124, v128, v129
v_cvt_pk_bf16_f32 v125, v130, v131
v_cvt_pk_bf16_f32 v126, v132, v133
v_cvt_pk_bf16_f32 v127, v134, v135
v_exp_f32 v136, v136
v_exp_f32 v137, v137
v_mfma_f32_32x32x16_bf16 v[152:167], v[60:63], v[124:127], v[152:167]
v_exp_f32 v138, v138
v_exp_f32 v139, v139
v_exp_f32 v140, v140
v_exp_f32 v141, v141
v_mfma_f32_32x32x8_bf16 v[120:135], v[18:19], v[188:189], 0
v_exp_f32 v142, v142
v_exp_f32 v143, v143
v_cvt_pk_bf16_f32 v136, v136, v137
v_cvt_pk_bf16_f32 v137, v138, v139
v_cvt_pk_bf16_f32 v138, v140, v141
v_cvt_pk_bf16_f32 v139, v142, v143
v_mfma_f32_32x32x16_bf16 v[120:135], v[32:35], v[184:187], v[120:135]
v_exp_f32 v144, v144
v_exp_f32 v145, v145
s_waitcnt lgkmcnt(0)
s_mov_b64 exec, 1
ds_write_b32 v8, v11 offset:3088
s_mov_b64 exec, -1
v_exp_f32 v146, v146
v_exp_f32 v147, v147
v_exp_f32 v148, v148
v_exp_f32 v149, v149
v_mfma_f32_32x32x16_bf16 v[152:167], v[64:67], v[136:139], v[152:167]
v_exp_f32 v150, v150
v_exp_f32 v151, v151
v_cvt_pk_bf16_f32 v140, v144, v145
v_cvt_pk_bf16_f32 v141, v146, v147
v_cvt_pk_bf16_f32 v142, v148, v149
v_cvt_pk_bf16_f32 v143, v150, v151
v_exp_f32 v120, v120
v_exp_f32 v121, v121
v_mfma_f32_32x32x16_bf16 v[152:167], v[68:71], v[140:143], v[152:167]
v_exp_f32 v122, v122
v_exp_f32 v123, v123
v_exp_f32 v124, v124
v_exp_f32 v125, v125
v_mfma_f32_32x32x8_bf16 v[136:151], v[18:19], v[190:191], 0
v_exp_f32 v126, v126
v_exp_f32 v127, v127
v_cvt_pk_bf16_f32 v120, v120, v121
v_cvt_pk_bf16_f32 v121, v122, v123
v_cvt_pk_bf16_f32 v122, v124, v125
v_cvt_pk_bf16_f32 v123, v126, v127
v_mfma_f32_32x32x16_bf16 v[136:151], v[36:39], v[184:187], v[136:151]
v_exp_f32 v128, v128
v_exp_f32 v129, v129
v_exp_f32 v130, v130
v_exp_f32 v131, v131
v_exp_f32 v132, v132
v_exp_f32 v133, v133
v_mfma_f32_32x32x16_bf16 v[152:167], v[72:75], v[120:123], v[152:167]
v_exp_f32 v134, v134
v_exp_f32 v135, v135
v_cvt_pk_bf16_f32 v124, v128, v129
v_cvt_pk_bf16_f32 v125, v130, v131
v_cvt_pk_bf16_f32 v126, v132, v133
v_cvt_pk_bf16_f32 v127, v134, v135
v_exp_f32 v136, v136
v_exp_f32 v137, v137
v_mfma_f32_32x32x16_bf16 v[152:167], v[76:79], v[124:127], v[152:167]
v_exp_f32 v138, v138
v_exp_f32 v139, v139
v_exp_f32 v140, v140
v_exp_f32 v141, v141
v_mfma_f32_32x32x8_bf16 v[120:135], v[20:21], v[188:189], 0
v_exp_f32 v142, v142
v_exp_f32 v143, v143
v_cvt_pk_bf16_f32 v136, v136, v137
v_cvt_pk_bf16_f32 v137, v138, v139
v_cvt_pk_bf16_f32 v138, v140, v141
v_cvt_pk_bf16_f32 v139, v142, v143
v_mfma_f32_32x32x16_bf16 v[120:135], v[40:43], v[184:187], v[120:135]
v_exp_f32 v144, v144
v_exp_f32 v145, v145
s_waitcnt vmcnt(3)
buffer_load_dword v251, v250, s[60:63], 0 offen sc1
v_and_b32 v14, 0xffff, v244
v_and_b32 v15, 0xffff0000, v244
v_dot2_f32_bf16 v200, v240, v14, 0
v_dot2_f32_bf16 v201, v240, v15, 0
v_and_b32 v14, 0xffff, v245
v_and_b32 v15, 0xffff0000, v245
v_dot2_f32_bf16 v202, v241, v14, 0
v_dot2_f32_bf16 v203, v241, v15, 0
v_and_b32 v14, 0xffff, v246
v_and_b32 v15, 0xffff0000, v246
v_dot2_f32_bf16 v204, v242, v14, 0
v_dot2_f32_bf16 v205, v242, v15, 0
v_and_b32 v14, 0xffff, v247
v_and_b32 v15, 0xffff0000, v247
v_dot2_f32_bf16 v206, v243, v14, 0
v_dot2_f32_bf16 v207, v243, v15, 0
v_mov_b32 v208, 0
v_mov_b32 v209, 0
v_mov_b32 v210, 0
v_mov_b32 v211, 0
v_mov_b32 v212, 0
v_mov_b32 v213, 0
v_mov_b32 v214, 0
v_mov_b32 v215, 0
s_mov_b32 s70, 0
v_exp_f32 v146, v146
v_exp_f32 v147, v147
v_exp_f32 v148, v148
v_exp_f32 v149, v149
v_mfma_f32_32x32x16_bf16 v[152:167], v[80:83], v[136:139], v[152:167]
v_exp_f32 v150, v150
v_exp_f32 v151, v151
v_cvt_pk_bf16_f32 v140, v144, v145
v_cvt_pk_bf16_f32 v141, v146, v147
v_cvt_pk_bf16_f32 v142, v148, v149
v_cvt_pk_bf16_f32 v143, v150, v151
v_exp_f32 v120, v120
v_exp_f32 v121, v121
v_mfma_f32_32x32x16_bf16 v[152:167], v[84:87], v[140:143], v[152:167]
v_exp_f32 v122, v122
v_exp_f32 v123, v123
v_exp_f32 v124, v124
v_exp_f32 v125, v125
v_mfma_f32_32x32x8_bf16 v[136:151], v[20:21], v[190:191], 0
v_exp_f32 v126, v126
v_exp_f32 v127, v127
v_cvt_pk_bf16_f32 v120, v120, v121
v_cvt_pk_bf16_f32 v121, v122, v123
v_cvt_pk_bf16_f32 v122, v124, v125
v_cvt_pk_bf16_f32 v123, v126, v127
v_mfma_f32_32x32x16_bf16 v[136:151], v[44:47], v[184:187], v[136:151]
v_exp_f32 v128, v128
v_exp_f32 v129, v129
ds_read_b32 v12, v10 offset:3088
v_exp_f32 v130, v130
v_exp_f32 v131, v131
v_exp_f32 v132, v132
v_exp_f32 v133, v133
v_mfma_f32_32x32x16_bf16 v[152:167], v[88:91], v[120:123], v[152:167]
v_exp_f32 v134, v134
v_exp_f32 v135, v135
v_cvt_pk_bf16_f32 v124, v128, v129
v_cvt_pk_bf16_f32 v125, v130, v131
v_cvt_pk_bf16_f32 v126, v132, v133
v_cvt_pk_bf16_f32 v127, v134, v135
v_exp_f32 v136, v136
v_exp_f32 v137, v137
v_mfma_f32_32x32x16_bf16 v[152:167], v[92:95], v[124:127], v[152:167]
v_exp_f32 v138, v138
v_exp_f32 v139, v139
v_exp_f32 v140, v140
v_exp_f32 v141, v141
v_mfma_f32_32x32x8_bf16 v[120:135], v[22:23], v[188:189], 0
v_exp_f32 v142, v142
v_exp_f32 v143, v143
v_cvt_pk_bf16_f32 v136, v136, v137
v_cvt_pk_bf16_f32 v137, v138, v139
v_cvt_pk_bf16_f32 v138, v140, v141
v_cvt_pk_bf16_f32 v139, v142, v143
v_mfma_f32_32x32x16_bf16 v[120:135], v[48:51], v[184:187], v[120:135]
v_exp_f32 v144, v144
v_exp_f32 v145, v145
s_mov_b32 s71, 0
k2_fpoll:
s_waitcnt vmcnt(0)
v_cmp_ne_u32 vcc, 1, v251
s_cbranch_vccz k2_fok
s_add_u32 s71, s71, 1
s_cmp_gt_u32 s71, 0x40000
s_cbranch_scc1 k2_fok
s_sleep 4
buffer_load_dword v251, v250, s[60:63], 0 offen sc1
s_branch k2_fpoll
k2_fok:
buffer_load_dwordx4 v[216:219], v249, s[60:63], s70 offen offset:0
buffer_load_dwordx4 v[220:223], v248, s[60:63], s70 offen offset:0 sc1
buffer_load_dwordx4 v[224:227], v249, s[60:63], s70 offen offset:1024
buffer_load_dwordx4 v[228:231], v248, s[60:63], s70 offen offset:1024 sc1
buffer_load_dwordx4 v[232:235], v249, s[60:63], s70 offen offset:2048
buffer_load_dwordx4 v[236:239], v248, s[60:63], s70 offen offset:2048 sc1
buffer_load_dwordx4 v[240:243], v249, s[60:63], s70 offen offset:3072
buffer_load_dwordx4 v[244:247], v248, s[60:63], s70 offen offset:3072 sc1
s_add_u32 s70, s70, 4096
k2_pollr2:
s_waitcnt lgkmcnt(0)
v_readfirstlane_b32 s9, v12
s_nop 0
s_cmp_lg_u32 s9, 0
s_cbranch_scc1 k2_okr2
s_sleep 2
ds_read_b32 v12, v10 offset:3088
s_branch k2_pollr2
k2_okr2:
ds_read_b128 v[168:171], v9 offset:2576
ds_read_b128 v[172:175], v9 offset:3600
ds_read_b64 v[176:177], v10 offset:2576
v_exp_f32 v146, v146
v_exp_f32 v147, v147
v_exp_f32 v148, v148
v_exp_f32 v149, v149
v_mfma_f32_32x32x16_bf16 v[152:167], v[96:99], v[136:139], v[152:167]
v_exp_f32 v150, v150
v_exp_f32 v151, v151
v_cvt_pk_bf16_f32 v140, v144, v145
v_cvt_pk_bf16_f32 v141, v146, v147
v_cvt_pk_bf16_f32 v142, v148, v149
v_cvt_pk_bf16_f32 v143, v150, v151
v_exp_f32 v120, v120
v_exp_f32 v121, v121
v_mfma_f32_32x32x16_bf16 v[152:167], v[100:103], v[140:143], v[152:167]
v_exp_f32 v122, v122
v_exp_f32 v123, v123
v_exp_f32 v124, v124
v_exp_f32 v125, v125
v_mfma_f32_32x32x8_bf16 v[136:151], v[22:23], v[190:191], 0
v_exp_f32 v126, v126
v_exp_f32 v127, v127
v_cvt_pk_bf16_f32 v120, v120, v121
v_cvt_pk_bf16_f32 v121, v122, v123
v_cvt_pk_bf16_f32 v122, v124, v125
v_cvt_pk_bf16_f32 v123, v126, v127
v_mfma_f32_32x32x16_bf16 v[136:151], v[52:55], v[184:187], v[136:151]
v_exp_f32 v128, v128
v_exp_f32 v129, v129
v_add_u32 v7, 5152, v7
v_add_u32 v8, 5152, v8
v_add_u32 v9, 5152, v9
v_add_u32 v10, 5152, v10
v_exp_f32 v130, v130
v_exp_f32 v131, v131
v_exp_f32 v132, v132
v_exp_f32 v133, v133
v_mfma_f32_32x32x16_bf16 v[152:167], v[104:107], v[120:123], v[152:167]
v_exp_f32 v134, v134
v_exp_f32 v135, v135
v_cvt_pk_bf16_f32 v124, v128, v129
v_cvt_pk_bf16_f32 v125, v130, v131
v_cvt_pk_bf16_f32 v126, v132, v133
v_cvt_pk_bf16_f32 v127, v134, v135
v_exp_f32 v136, v136
v_exp_f32 v137, v137
v_mfma_f32_32x32x16_bf16 v[152:167], v[108:111], v[124:127], v[152:167]
v_exp_f32 v138, v138
v_exp_f32 v139, v139
v_exp_f32 v140, v140
v_exp_f32 v141, v141
v_mfma_f32_32x32x8_bf16 v[120:135], v[16:17], v[196:197], 0
v_exp_f32 v142, v142
v_exp_f32 v143, v143
v_cvt_pk_bf16_f32 v136, v136, v137
v_cvt_pk_bf16_f32 v137, v138, v139
v_cvt_pk_bf16_f32 v138, v140, v141
v_cvt_pk_bf16_f32 v139, v142, v143
v_mfma_f32_32x32x16_bf16 v[120:135], v[24:27], v[192:195], v[120:135]
v_exp_f32 v144, v144
v_exp_f32 v145, v145
v_exp_f32 v146, v146
v_exp_f32 v147, v147
v_exp_f32 v148, v148
v_exp_f32 v149, v149
s_waitcnt lgkmcnt(0)
v_mfma_f32_32x32x16_bf16 v[152:167], v[112:115], v[136:139], v[152:167]
v_exp_f32 v150, v150
v_exp_f32 v151, v151
v_cvt_pk_bf16_f32 v140, v144, v145
v_cvt_pk_bf16_f32 v141, v146, v147
v_cvt_pk_bf16_f32 v142, v148, v149
v_cvt_pk_bf16_f32 v143, v150, v151
k2_loop:
v_exp_f32 v120, v120
v_exp_f32 v121, v121
v_mfma_f32_32x32x16_bf16 v[152:167], v[116:119], v[140:143], v[152:167]
v_exp_f32 v122, v122
v_exp_f32 v123, v123
v_exp_f32 v124, v124
v_exp_f32 v125, v125
v_mfma_f32_32x32x8_bf16 v[136:151], v[16:17], v[198:199], 0
v_exp_f32 v126, v126
v_exp_f32 v127, v127
v_cvt_pk_bf16_f32 v120, v120, v121
v_cvt_pk_bf16_f32 v121, v122, v123
v_cvt_pk_bf16_f32 v122, v124, v125
v_cvt_pk_bf16_f32 v123, v126, v127
v_mfma_f32_32x32x16_bf16 v[136:151], v[28:31], v[192:195], v[136:151]
v_exp_f32 v128, v128
v_exp_f32 v129, v129
ds_write_b128 v7, v[152:155] offset:0
ds_write_b128 v7, v[156:159] offset:1024
ds_write_b64 v8, v[160:161] offset:0
s_add_u32 s69, s69, 1
s_and_b32 s9, s69, 7
s_mul_i32 s9, s9, 144
s_add_u32 s9, s9, s8
buffer_load_dwordx4 v[184:187], v2, s[52:55], s9 offen
buffer_load_dword v188, v3, s[52:55], s9 offen
buffer_load_dword v190, v4, s[52:55], s9 offen
v_exp_f32 v130, v130
v_exp_f32 v131, v131
v_mfma_f32_32x32x16_bf16 v[168:183], v[56:59], v[120:123], v[168:183]
v_exp_f32 v132, v132
v_exp_f32 v133, v133
v_exp_f32 v134, v134
v_exp_f32 v135, v135
s_waitcnt vmcnt(9)
v_mfma_f32_32x32x16_bf16 v[200:215], v[216:219], v[220:223], v[200:215]
v_cvt_pk_bf16_f32 v124, v128, v129
v_cvt_pk_bf16_f32 v125, v130, v131
v_cvt_pk_bf16_f32 v126, v132, v133
v_cvt_pk_bf16_f32 v127, v134, v135
buffer_load_dwordx4 v[216:219], v249, s[60:63], s70 offen offset:0
buffer_load_dwordx4 v[220:223], v248, s[60:63], s70 offen offset:0 sc1
v_exp_f32 v136, v136
v_exp_f32 v137, v137
v_mfma_f32_32x32x16_bf16 v[168:183], v[60:63], v[124:127], v[168:183]
v_exp_f32 v138, v138
v_exp_f32 v139, v139
v_exp_f32 v140, v140
v_exp_f32 v141, v141
v_mfma_f32_32x32x8_bf16 v[120:135], v[18:19], v[196:197], 0
v_exp_f32 v142, v142
v_exp_f32 v143, v143
v_cvt_pk_bf16_f32 v136, v136, v137
v_cvt_pk_bf16_f32 v137, v138, v139
v_cvt_pk_bf16_f32 v138, v140, v141
v_cvt_pk_bf16_f32 v139, v142, v143
v_mfma_f32_32x32x16_bf16 v[120:135], v[32:35], v[192:195], v[120:135]
v_exp_f32 v144, v144
v_exp_f32 v145, v145
s_waitcnt lgkmcnt(0)
s_mov_b64 exec, 1
ds_write_b32 v8, v11 offset:512
s_mov_b64 exec, -1
v_exp_f32 v146, v146
v_exp_f32 v147, v147
v_mfma_f32_32x32x16_bf16 v[168:183], v[64:67], v[136:139], v[168:183]
v_exp_f32 v148, v148
v_exp_f32 v149, v149
v_exp_f32 v150, v150
v_exp_f32 v151, v151
s_waitcnt vmcnt(9)
v_mfma_f32_32x32x16_bf16 v[200:215], v[224:227], v[228:231], v[200:215]
v_cvt_pk_bf16_f32 v140, v144, v145
v_cvt_pk_bf16_f32 v141, v146, v147
v_cvt_pk_bf16_f32 v142, v148, v149
v_cvt_pk_bf16_f32 v143, v150, v151
buffer_load_dwordx4 v[224:227], v249, s[60:63], s70 offen offset:1024
buffer_load_dwordx4 v[228:231], v248, s[60:63], s70 offen offset:1024 sc1
v_exp_f32 v120, v120
v_exp_f32 v121, v121
v_mfma_f32_32x32x16_bf16 v[168:183], v[68:71], v[140:143], v[168:183]
v_exp_f32 v122, v122
v_exp_f32 v123, v123
v_exp_f32 v124, v124
v_exp_f32 v125, v125
v_mfma_f32_32x32x8_bf16 v[136:151], v[18:19], v[198:199], 0
v_exp_f32 v126, v126
v_exp_f32 v127, v127
v_cvt_pk_bf16_f32 v120, v120, v121
v_cvt_pk_bf16_f32 v121, v122, v123
v_cvt_pk_bf16_f32 v122, v124, v125
v_cvt_pk_bf16_f32 v123, v126, v127
v_mfma_f32_32x32x16_bf16 v[136:151], v[36:39], v[192:195], v[136:151]
v_exp_f32 v128, v128
v_exp_f32 v129, v129
v_exp_f32 v130, v130
v_exp_f32 v131, v131
v_mfma_f32_32x32x16_bf16 v[168:183], v[72:75], v[120:123], v[168:183]
v_exp_f32 v132, v132
v_exp_f32 v133, v133
v_exp_f32 v134, v134
v_exp_f32 v135, v135
s_waitcnt vmcnt(9)
v_mfma_f32_32x32x16_bf16 v[200:215], v[232:235], v[236:239], v[200:215]
v_cvt_pk_bf16_f32 v124, v128, v129
v_cvt_pk_bf16_f32 v125, v130, v131
v_cvt_pk_bf16_f32 v126, v132, v133
v_cvt_pk_bf16_f32 v127, v134, v135
buffer_load_dwordx4 v[232:235], v249, s[60:63], s70 offen offset:2048
buffer_load_dwordx4 v[236:239], v248, s[60:63], s70 offen offset:2048 sc1
v_exp_f32 v136, v136
v_exp_f32 v137, v137
v_mfma_f32_32x32x16_bf16 v[168:183], v[76:79], v[124:127], v[168:183]
v_exp_f32 v138, v138
v_exp_f32 v139, v139
v_exp_f32 v140, v140
v_exp_f32 v141, v141
v_mfma_f32_32x32x8_bf16 v[120:135], v[20:21], v[196:197], 0
v_exp_f32 v142, v142
v_exp_f32 v143, v143
v_cvt_pk_bf16_f32 v136, v136, v137
v_cvt_pk_bf16_f32 v137, v138, v139
v_cvt_pk_bf16_f32 v138, v140, v141
v_cvt_pk_bf16_f32 v139, v142, v143
v_mfma_f32_32x32x16_bf16 v[120:135], v[40:43], v[192:195], v[120:135]
v_exp_f32 v144, v144
v_exp_f32 v145, v145
v_exp_f32 v146, v146
v_exp_f32 v147, v147
v_mfma_f32_32x32x16_bf16 v[168:183], v[80:83], v[136:139], v[168:183]
v_exp_f32 v148, v148
v_exp_f32 v149, v149
v_exp_f32 v150, v150
v_exp_f32 v151, v151
s_waitcnt vmcnt(9)
v_mfma_f32_32x32x16_bf16 v[200:215], v[240:243], v[244:247], v[200:215]
v_cvt_pk_bf16_f32 v140, v144, v145
v_cvt_pk_bf16_f32 v141, v146, v147
v_cvt_pk_bf16_f32 v142, v148, v149
v_cvt_pk_bf16_f32 v143, v150, v151
buffer_load_dwordx4 v[240:243], v249, s[60:63], s70 offen offset:3072
buffer_load_dwordx4 v[244:247], v248, s[60:63], s70 offen offset:3072 sc1
s_add_u32 s70, s70, 4096
v_exp_f32 v120, v120
v_exp_f32 v121, v121
v_mfma_f32_32x32x16_bf16 v[168:183], v[84:87], v[140:143], v[168:183]
v_exp_f32 v122, v122
v_exp_f32 v123, v123
v_exp_f32 v124, v124
v_exp_f32 v125, v125
v_mfma_f32_32x32x8_bf16 v[136:151], v[20:21], v[198:199], 0
v_exp_f32 v126, v126
v_exp_f32 v127, v127
v_cvt_pk_bf16_f32 v120, v120, v121
v_cvt_pk_bf16_f32 v121, v122, v123
v_cvt_pk_bf16_f32 v122, v124, v125
v_cvt_pk_bf16_f32 v123, v126, v127
v_mfma_f32_32x32x16_bf16 v[136:151], v[44:47], v[192:195], v[136:151]
v_exp_f32 v128, v128
v_exp_f32 v129, v129
ds_read_b32 v12, v10 offset:512
v_exp_f32 v130, v130
v_exp_f32 v131, v131
v_mfma_f32_32x32x16_bf16 v[168:183], v[88:91], v[120:123], v[168:183]
v_exp_f32 v132, v132
v_exp_f32 v133, v133
v_exp_f32 v134, v134
v_exp_f32 v135, v135
s_waitcnt vmcnt(6)
v_mfma_f32_32x32x16_bf16 v[200:215], v[216:219], v[220:223], v[200:215]
v_cvt_pk_bf16_f32 v124, v128, v129
v_cvt_pk_bf16_f32 v125, v130, v131
v_cvt_pk_bf16_f32 v126, v132, v133
v_cvt_pk_bf16_f32 v127, v134, v135
buffer_load_dwordx4 v[216:219], v249, s[60:63], s70 offen offset:0
buffer_load_dwordx4 v[220:223], v248, s[60:63], s70 offen offset:0 sc1
v_exp_f32 v136, v136
v_exp_f32 v137, v137
v_mfma_f32_32x32x16_bf16 v[168:183], v[92:95], v[124:127], v[168:183]
v_exp_f32 v138, v138
v_exp_f32 v139, v139
v_exp_f32 v140, v140
v_exp_f32 v141, v141
v_mfma_f32_32x32x8_bf16 v[120:135], v[22:23], v[196:197], 0
v_exp_f32 v142, v142
v_exp_f32 v143, v143
v_cvt_pk_bf16_f32 v136, v136, v137
v_cvt_pk_bf16_f32 v137, v138, v139
v_cvt_pk_bf16_f32 v138, v140, v141
v_cvt_pk_bf16_f32 v139, v142, v143
v_mfma_f32_32x32x16_bf16 v[120:135], v[48:51], v[192:195], v[120:135]
v_exp_f32 v144, v144
v_exp_f32 v145, v145
k2_pollr3:
s_waitcnt lgkmcnt(0)
v_readfirstlane_b32 s9, v12
s_nop 0
s_cmp_lg_u32 s9, 0
s_cbranch_scc1 k2_okr3
s_sleep 2
ds_read_b32 v12, v10 offset:512
s_branch k2_pollr3
k2_okr3:
ds_read_b128 v[152:155], v9 offset:0
ds_read_b128 v[156:159], v9 offset:1024
ds_read_b64 v[160:161], v10 offset:0
v_exp_f32 v146, v146
v_exp_f32 v147, v147
v_mfma_f32_32x32x16_bf16 v[168:183], v[96:99], v[136:139], v[168:183]
v_exp_f32 v148, v148
v_exp_f32 v149, v149
v_exp_f32 v150, v150
v_exp_f32 v151, v151
s_waitcnt vmcnt(6)
v_mfma_f32_32x32x16_bf16 v[200:215], v[224:227], v[228:231], v[200:215]
v_cvt_pk_bf16_f32 v140, v144, v145
v_cvt_pk_bf16_f32 v141, v146, v147
v_cvt_pk_bf16_f32 v142, v148, v149
v_cvt_pk_bf16_f32 v143, v150, v151
buffer_load_dwordx4 v[224:227], v249, s[60:63], s70 offen offset:1024
buffer_load_dwordx4 v[228:231], v248, s[60:63], s70 offen offset:1024 sc1
v_exp_f32 v120, v120
v_exp_f32 v121, v121
v_mfma_f32_32x32x16_bf16 v[168:183], v[100:103], v[140:143], v[168:183]
v_exp_f32 v122, v122
v_exp_f32 v123, v123
v_exp_f32 v124, v124
v_exp_f32 v125, v125
v_mfma_f32_32x32x8_bf16 v[136:151], v[22:23], v[198:199], 0
v_exp_f32 v126, v126
v_exp_f32 v127, v127
v_cvt_pk_bf16_f32 v120, v120, v121
v_cvt_pk_bf16_f32 v121, v122, v123
v_cvt_pk_bf16_f32 v122, v124, v125
v_cvt_pk_bf16_f32 v123, v126, v127
v_mfma_f32_32x32x16_bf16 v[136:151], v[52:55], v[192:195], v[136:151]
v_exp_f32 v128, v128
v_exp_f32 v129, v129
v_exp_f32 v130, v130
v_exp_f32 v131, v131
v_mfma_f32_32x32x16_bf16 v[168:183], v[104:107], v[120:123], v[168:183]
v_exp_f32 v132, v132
v_exp_f32 v133, v133
v_exp_f32 v134, v134
v_exp_f32 v135, v135
s_waitcnt vmcnt(6)
v_mfma_f32_32x32x16_bf16 v[200:215], v[232:235], v[236:239], v[200:215]
v_cvt_pk_bf16_f32 v124, v128, v129
v_cvt_pk_bf16_f32 v125, v130, v131
v_cvt_pk_bf16_f32 v126, v132, v133
v_cvt_pk_bf16_f32 v127, v134, v135
buffer_load_dwordx4 v[232:235], v249, s[60:63], s70 offen offset:2048
buffer_load_dwordx4 v[236:239], v248, s[60:63], s70 offen offset:2048 sc1
v_exp_f32 v136, v136
v_exp_f32 v137, v137
v_mfma_f32_32x32x16_bf16 v[168:183], v[108:111], v[124:127], v[168:183]
v_exp_f32 v138, v138
v_exp_f32 v139, v139
v_exp_f32 v140, v140
v_exp_f32 v141, v141
v_mfma_f32_32x32x8_bf16 v[120:135], v[16:17], v[188:189], 0
v_exp_f32 v142, v142
v_exp_f32 v143, v143
v_cvt_pk_bf16_f32 v136, v136, v137
v_cvt_pk_bf16_f32 v137, v138, v139
v_cvt_pk_bf16_f32 v138, v140, v141
v_cvt_pk_bf16_f32 v139, v142, v143
v_mfma_f32_32x32x16_bf16 v[120:135], v[24:27], v[184:187], v[120:135]
v_exp_f32 v144, v144
v_exp_f32 v145, v145
v_exp_f32 v146, v146
v_exp_f32 v147, v147
s_waitcnt lgkmcnt(0)
v_mfma_f32_32x32x16_bf16 v[168:183], v[112:115], v[136:139], v[168:183]
v_exp_f32 v148, v148
v_exp_f32 v149, v149
v_exp_f32 v150, v150
v_exp_f32 v151, v151
s_waitcnt vmcnt(6)
v_mfma_f32_32x32x16_bf16 v[200:215], v[240:243], v[244:247], v[200:215]
v_cvt_pk_bf16_f32 v140, v144, v145
v_cvt_pk_bf16_f32 v141, v146, v147
v_cvt_pk_bf16_f32 v142, v148, v149
v_cvt_pk_bf16_f32 v143, v150, v151
buffer_load_dwordx4 v[240:243], v249, s[60:63], s70 offen offset:3072
buffer_load_dwordx4 v[244:247], v248, s[60:63], s70 offen offset:3072 sc1
s_add_u32 s70, s70, 4096
v_exp_f32 v120, v120
v_exp_f32 v121, v121
v_mfma_f32_32x32x16_bf16 v[168:183], v[116:119], v[140:143], v[168:183]
v_exp_f32 v122, v122
v_exp_f32 v123, v123
v_exp_f32 v124, v124
v_exp_f32 v125, v125
v_mfma_f32_32x32x8_bf16 v[136:151], v[16:17], v[190:191], 0
v_exp_f32 v126, v126
v_exp_f32 v127, v127
v_cvt_pk_bf16_f32 v120, v120, v121
v_cvt_pk_bf16_f32 v121, v122, v123
v_cvt_pk_bf16_f32 v122, v124, v125
v_cvt_pk_bf16_f32 v123, v126, v127
v_mfma_f32_32x32x16_bf16 v[136:151], v[28:31], v[184:187], v[136:151]
v_exp_f32 v128, v128
v_exp_f32 v129, v129
ds_write_b128 v7, v[168:171] offset:2576
ds_write_b128 v7, v[172:175] offset:3600
ds_write_b64 v8, v[176:177] offset:2576
s_add_u32 s69, s69, 1
s_and_b32 s9, s69, 7
s_mul_i32 s9, s9, 144
s_add_u32 s9, s9, s8
buffer_load_dwordx4 v[192:195], v2, s[52:55], s9 offen
buffer_load_dword v196, v3, s[52:55], s9 offen
buffer_load_dword v198, v4, s[52:55], s9 offen
v_exp_f32 v130, v130
v_exp_f32 v131, v131
v_mfma_f32_32x32x16_bf16 v[152:167], v[56:59], v[120:123], v[152:167]
v_exp_f32 v132, v132
v_exp_f32 v133, v133
v_exp_f32 v134, v134
v_exp_f32 v135, v135
s_waitcnt vmcnt(9)
v_mfma_f32_32x32x16_bf16 v[200:215], v[216:219], v[220:223], v[200:215]
v_cvt_pk_bf16_f32 v124, v128, v129
v_cvt_pk_bf16_f32 v125, v130, v131
v_cvt_pk_bf16_f32 v126, v132, v133
v_cvt_pk_bf16_f32 v127, v134, v135
buffer_load_dwordx4 v[216:219], v249, s[60:63], s70 offen offset:0
buffer_load_dwordx4 v[220:223], v248, s[60:63], s70 offen offset:0 sc1
v_exp_f32 v136, v136
v_exp_f32 v137, v137
v_mfma_f32_32x32x16_bf16 v[152:167], v[60:63], v[124:127], v[152:167]
v_exp_f32 v138, v138
v_exp_f32 v139, v139
v_exp_f32 v140, v140
v_exp_f32 v141, v141
v_mfma_f32_32x32x8_bf16 v[120:135], v[18:19], v[188:189], 0
v_exp_f32 v142, v142
v_exp_f32 v143, v143
v_cvt_pk_bf16_f32 v136, v136, v137
v_cvt_pk_bf16_f32 v137, v138, v139
v_cvt_pk_bf16_f32 v138, v140, v141
v_cvt_pk_bf16_f32 v139, v142, v143
v_mfma_f32_32x32x16_bf16 v[120:135], v[32:35], v[184:187], v[120:135]
v_exp_f32 v144, v144
v_exp_f32 v145, v145
s_waitcnt lgkmcnt(0)
s_mov_b64 exec, 1
ds_write_b32 v8, v11 offset:3088
s_mov_b64 exec, -1
v_exp_f32 v146, v146
v_exp_f32 v147, v147
v_mfma_f32_32x32x16_bf16 v[152:167], v[64:67], v[136:139], v[152:167]
v_exp_f32 v148, v148
v_exp_f32 v149, v149
v_exp_f32 v150, v150
v_exp_f32 v151, v151
s_waitcnt vmcnt(9)
v_mfma_f32_32x32x16_bf16 v[200:215], v[224:227], v[228:231], v[200:215]
v_cvt_pk_bf16_f32 v140, v144, v145
v_cvt_pk_bf16_f32 v141, v146, v147
v_cvt_pk_bf16_f32 v142, v148, v149
v_cvt_pk_bf16_f32 v143, v150, v151
buffer_load_dwordx4 v[224:227], v249, s[60:63], s70 offen offset:1024
buffer_load_dwordx4 v[228:231], v248, s[60:63], s70 offen offset:1024 sc1
v_exp_f32 v120, v120
v_exp_f32 v121, v121
v_mfma_f32_32x32x16_bf16 v[152:167], v[68:71], v[140:143], v[152:167]
v_exp_f32 v122, v122
v_exp_f32 v123, v123
v_exp_f32 v124, v124
v_exp_f32 v125, v125
v_mfma_f32_32x32x8_bf16 v[136:151], v[18:19], v[190:191], 0
v_exp_f32 v126, v126
v_exp_f32 v127, v127
v_cvt_pk_bf16_f32 v120, v120, v121
v_cvt_pk_bf16_f32 v121, v122, v123
v_cvt_pk_bf16_f32 v122, v124, v125
v_cvt_pk_bf16_f32 v123, v126, v127
v_mfma_f32_32x32x16_bf16 v[136:151], v[36:39], v[184:187], v[136:151]
v_exp_f32 v128, v128
v_exp_f32 v129, v129
v_exp_f32 v130, v130
v_exp_f32 v131, v131
v_mfma_f32_32x32x16_bf16 v[152:167], v[72:75], v[120:123], v[152:167]
v_exp_f32 v132, v132
v_exp_f32 v133, v133
v_exp_f32 v134, v134
v_exp_f32 v135, v135
s_waitcnt vmcnt(9)
v_mfma_f32_32x32x16_bf16 v[200:215], v[232:235], v[236:239], v[200:215]
v_cvt_pk_bf16_f32 v124, v128, v129
v_cvt_pk_bf16_f32 v125, v130, v131
v_cvt_pk_bf16_f32 v126, v132, v133
v_cvt_pk_bf16_f32 v127, v134, v135
buffer_load_dwordx4 v[232:235], v249, s[60:63], s70 offen offset:2048
buffer_load_dwordx4 v[236:239], v248, s[60:63], s70 offen offset:2048 sc1
v_exp_f32 v136, v136
v_exp_f32 v137, v137
v_mfma_f32_32x32x16_bf16 v[152:167], v[76:79], v[124:127], v[152:167]
v_exp_f32 v138, v138
v_exp_f32 v139, v139
v_exp_f32 v140, v140
v_exp_f32 v141, v141
v_mfma_f32_32x32x8_bf16 v[120:135], v[20:21], v[188:189], 0
v_exp_f32 v142, v142
v_exp_f32 v143, v143
v_cvt_pk_bf16_f32 v136, v136, v137
v_cvt_pk_bf16_f32 v137, v138, v139
v_cvt_pk_bf16_f32 v138, v140, v141
v_cvt_pk_bf16_f32 v139, v142, v143
v_mfma_f32_32x32x16_bf16 v[120:135], v[40:43], v[184:187], v[120:135]
v_exp_f32 v144, v144
v_exp_f32 v145, v145
v_exp_f32 v146, v146
v_exp_f32 v147, v147
v_mfma_f32_32x32x16_bf16 v[152:167], v[80:83], v[136:139], v[152:167]
v_exp_f32 v148, v148
v_exp_f32 v149, v149
v_exp_f32 v150, v150
v_exp_f32 v151, v151
s_waitcnt vmcnt(9)
v_mfma_f32_32x32x16_bf16 v[200:215], v[240:243], v[244:247], v[200:215]
v_cvt_pk_bf16_f32 v140, v144, v145
v_cvt_pk_bf16_f32 v141, v146, v147
v_cvt_pk_bf16_f32 v142, v148, v149
v_cvt_pk_bf16_f32 v143, v150, v151
buffer_load_dwordx4 v[240:243], v249, s[60:63], s70 offen offset:3072
buffer_load_dwordx4 v[244:247], v248, s[60:63], s70 offen offset:3072 sc1
s_add_u32 s70, s70, 4096
v_exp_f32 v120, v120
v_exp_f32 v121, v121
v_mfma_f32_32x32x16_bf16 v[152:167], v[84:87], v[140:143], v[152:167]
v_exp_f32 v122, v122
v_exp_f32 v123, v123
v_exp_f32 v124, v124
v_exp_f32 v125, v125
v_mfma_f32_32x32x8_bf16 v[136:151], v[20:21], v[190:191], 0
v_exp_f32 v126, v126
v_exp_f32 v127, v127
v_cvt_pk_bf16_f32 v120, v120, v121
v_cvt_pk_bf16_f32 v121, v122, v123
v_cvt_pk_bf16_f32 v122, v124, v125
v_cvt_pk_bf16_f32 v123, v126, v127
v_mfma_f32_32x32x16_bf16 v[136:151], v[44:47], v[184:187], v[136:151]
v_exp_f32 v128, v128
v_exp_f32 v129, v129
ds_read_b32 v12, v10 offset:3088
v_exp_f32 v130, v130
v_exp_f32 v131, v131
v_mfma_f32_32x32x16_bf16 v[152:167], v[88:91], v[120:123], v[152:167]
v_exp_f32 v132, v132
v_exp_f32 v133, v133
v_exp_f32 v134, v134
v_exp_f32 v135, v135
s_waitcnt vmcnt(6)
v_mfma_f32_32x32x16_bf16 v[200:215], v[216:219], v[220:223], v[200:215]
v_cvt_pk_bf16_f32 v124, v128, v129
v_cvt_pk_bf16_f32 v125, v130, v131
v_cvt_pk_bf16_f32 v126, v132, v133
v_cvt_pk_bf16_f32 v127, v134, v135
buffer_load_dwordx4 v[216:219], v249, s[60:63], s70 offen offset:0
buffer_load_dwordx4 v[220:223], v248, s[60:63], s70 offen offset:0 sc1
v_exp_f32 v136, v136
v_exp_f32 v137, v137
v_mfma_f32_32x32x16_bf16 v[152:167], v[92:95], v[124:127], v[152:167]
v_exp_f32 v138, v138
v_exp_f32 v139, v139
v_exp_f32 v140, v140
v_exp_f32 v141, v141
v_mfma_f32_32x32x8_bf16 v[120:135], v[22:23], v[188:189], 0
v_exp_f32 v142, v142
v_exp_f32 v143, v143
v_cvt_pk_bf16_f32 v136, v136, v137
v_cvt_pk_bf16_f32 v137, v138, v139
v_cvt_pk_bf16_f32 v138, v140, v141
v_cvt_pk_bf16_f32 v139, v142, v143
v_mfma_f32_32x32x16_bf16 v[120:135], v[48:51], v[184:187], v[120:135]
v_exp_f32 v144, v144
v_exp_f32 v145, v145
k2_pollr4:
s_waitcnt lgkmcnt(0)
v_readfirstlane_b32 s9, v12
s_nop 0
s_cmp_lg_u32 s9, 0
s_cbranch_scc1 k2_okr4
s_sleep 2
ds_read_b32 v12, v10 offset:3088
s_branch k2_pollr4
k2_okr4:
ds_read_b128 v[168:171], v9 offset:2576
ds_read_b128 v[172:175], v9 offset:3600
ds_read_b64 v[176:177], v10 offset:2576
v_exp_f32 v146, v146
v_exp_f32 v147, v147
v_mfma_f32_32x32x16_bf16 v[152:167], v[96:99], v[136:139], v[152:167]
v_exp_f32 v148, v148
v_exp_f32 v149, v149
v_exp_f32 v150, v150
v_exp_f32 v151, v151
s_waitcnt vmcnt(6)
v_mfma_f32_32x32x16_bf16 v[200:215], v[224:227], v[228:231], v[200:215]
v_cvt_pk_bf16_f32 v140, v144, v145
v_cvt_pk_bf16_f32 v141, v146, v147
v_cvt_pk_bf16_f32 v142, v148, v149
v_cvt_pk_bf16_f32 v143, v150, v151
buffer_load_dwordx4 v[224:227], v249, s[60:63], s70 offen offset:1024
buffer_load_dwordx4 v[228:231], v248, s[60:63], s70 offen offset:1024 sc1
v_exp_f32 v120, v120
v_exp_f32 v121, v121
v_mfma_f32_32x32x16_bf16 v[152:167], v[100:103], v[140:143], v[152:167]
v_exp_f32 v122, v122
v_exp_f32 v123, v123
v_exp_f32 v124, v124
v_exp_f32 v125, v125
v_mfma_f32_32x32x8_bf16 v[136:151], v[22:23], v[190:191], 0
v_exp_f32 v126, v126
v_exp_f32 v127, v127
v_cvt_pk_bf16_f32 v120, v120, v121
v_cvt_pk_bf16_f32 v121, v122, v123
v_cvt_pk_bf16_f32 v122, v124, v125
v_cvt_pk_bf16_f32 v123, v126, v127
v_mfma_f32_32x32x16_bf16 v[136:151], v[52:55], v[184:187], v[136:151]
v_exp_f32 v128, v128
v_exp_f32 v129, v129
v_add_u32 v7, 5152, v7
v_add_u32 v8, 5152, v8
s_cmp_eq_u32 s4, 1
s_cselect_b32 s9, s12, 0
s_add_u32 s9, s9, 5152
v_add_u32 v9, s9, v9
v_add_u32 v10, s9, v10
v_exp_f32 v130, v130
v_exp_f32 v131, v131
v_mfma_f32_32x32x16_bf16 v[152:167], v[104:107], v[120:123], v[152:167]
v_exp_f32 v132, v132
v_exp_f32 v133, v133
v_exp_f32 v134, v134
v_exp_f32 v135, v135
s_waitcnt vmcnt(6)
v_mfma_f32_32x32x16_bf16 v[200:215], v[232:235], v[236:239], v[200:215]
v_cvt_pk_bf16_f32 v124, v128, v129
v_cvt_pk_bf16_f32 v125, v130, v131
v_cvt_pk_bf16_f32 v126, v132, v133
v_cvt_pk_bf16_f32 v127, v134, v135
buffer_load_dwordx4 v[232:235], v249, s[60:63], s70 offen offset:2048
buffer_load_dwordx4 v[236:239], v248, s[60:63], s70 offen offset:2048 sc1
v_exp_f32 v136, v136
v_exp_f32 v137, v137
v_mfma_f32_32x32x16_bf16 v[152:167], v[108:111], v[124:127], v[152:167]
v_exp_f32 v138, v138
v_exp_f32 v139, v139
v_exp_f32 v140, v140
v_exp_f32 v141, v141
v_mfma_f32_32x32x8_bf16 v[120:135], v[16:17], v[196:197], 0
v_exp_f32 v142, v142
v_exp_f32 v143, v143
v_cvt_pk_bf16_f32 v136, v136, v137
v_cvt_pk_bf16_f32 v137, v138, v139
v_cvt_pk_bf16_f32 v138, v140, v141
v_cvt_pk_bf16_f32 v139, v142, v143
v_mfma_f32_32x32x16_bf16 v[120:135], v[24:27], v[192:195], v[120:135]
v_exp_f32 v144, v144
v_exp_f32 v145, v145
v_exp_f32 v146, v146
v_exp_f32 v147, v147
s_waitcnt lgkmcnt(0)
v_mfma_f32_32x32x16_bf16 v[152:167], v[112:115], v[136:139], v[152:167]
v_exp_f32 v148, v148
v_exp_f32 v149, v149
v_exp_f32 v150, v150
v_exp_f32 v151, v151
s_waitcnt vmcnt(6)
v_mfma_f32_32x32x16_bf16 v[200:215], v[240:243], v[244:247], v[200:215]
v_cvt_pk_bf16_f32 v140, v144, v145
v_cvt_pk_bf16_f32 v141, v146, v147
v_cvt_pk_bf16_f32 v142, v148, v149
v_cvt_pk_bf16_f32 v143, v150, v151
buffer_load_dwordx4 v[240:243], v249, s[60:63], s70 offen offset:3072
buffer_load_dwordx4 v[244:247], v248, s[60:63], s70 offen offset:3072 sc1
s_add_u32 s70, s70, 4096
s_add_u32 s4, s4, 1
s_cmp_lt_u32 s4, 2
s_cbranch_scc1 k2_loop
v_exp_f32 v120, v120
v_exp_f32 v121, v121
v_mfma_f32_32x32x16_bf16 v[152:167], v[116:119], v[140:143], v[152:167]
v_exp_f32 v122, v122
v_exp_f32 v123, v123
v_exp_f32 v124, v124
v_exp_f32 v125, v125
v_mfma_f32_32x32x8_bf16 v[136:151], v[16:17], v[198:199], 0
v_exp_f32 v126, v126
v_exp_f32 v127, v127
v_cvt_pk_bf16_f32 v120, v120, v121
v_cvt_pk_bf16_f32 v121, v122, v123
v_cvt_pk_bf16_f32 v122, v124, v125
v_cvt_pk_bf16_f32 v123, v126, v127
v_mfma_f32_32x32x16_bf16 v[136:151], v[28:31], v[192:195], v[136:151]
v_exp_f32 v128, v128
v_exp_f32 v129, v129
ds_write_b128 v7, v[152:155] offset:0
ds_write_b128 v7, v[156:159] offset:1024
ds_write_b64 v8, v[160:161] offset:0
v_exp_f32 v130, v130
v_exp_f32 v131, v131
v_mfma_f32_32x32x16_bf16 v[168:183], v[56:59], v[120:123], v[168:183]
v_exp_f32 v132, v132
v_exp_f32 v133, v133
v_exp_f32 v134, v134
v_exp_f32 v135, v135
s_waitcnt vmcnt(6)
v_mfma_f32_32x32x16_bf16 v[200:215], v[216:219], v[220:223], v[200:215]
v_cvt_pk_bf16_f32 v124, v128, v129
v_cvt_pk_bf16_f32 v125, v130, v131
v_cvt_pk_bf16_f32 v126, v132, v133
v_cvt_pk_bf16_f32 v127, v134, v135
v_exp_f32 v136, v136
v_exp_f32 v137, v137
v_mfma_f32_32x32x16_bf16 v[168:183], v[60:63], v[124:127], v[168:183]
v_exp_f32 v138, v138
v_exp_f32 v139, v139
v_exp_f32 v140, v140
v_exp_f32 v141, v141
v_mfma_f32_32x32x8_bf16 v[120:135], v[18:19], v[196:197], 0
v_exp_f32 v142, v142
v_exp_f32 v143, v143
v_cvt_pk_bf16_f32 v136, v136, v137
v_cvt_pk_bf16_f32 v137, v138, v139
v_cvt_pk_bf16_f32 v138, v140, v141
v_cvt_pk_bf16_f32 v139, v142, v143
v_mfma_f32_32x32x16_bf16 v[120:135], v[32:35], v[192:195], v[120:135]
v_exp_f32 v144, v144
v_exp_f32 v145, v145
s_waitcnt lgkmcnt(0)
s_mov_b64 exec, 1
ds_write_b32 v8, v11 offset:512
s_mov_b64 exec, -1
s_mov_b32 s72, s44
s_and_b32 s73, s45, 0xffff
s_mov_b32 s74, 9437184
s_mov_b32 s75, 0x20000
s_mov_b32 s9, s68
v_lshrrev_b32 v248, 5, v0
v_lshlrev_b32 v248, 3, v248
v_and_b32 v249, 31, v0
v_mul_u32_u24 v249, 4608, v249
v_lshl_add_u32 v249, v248, 1, v249
s_lshr_b32 s10, s2, 2
s_mul_i32 s10, s10, 147456
s_lshl_b32 s9, s9, 1
s_add_u32 s70, s10, s9
s_lshl_b32 s9, s3, 11
s_add_u32 s9, s9, 146832
v_add_u32 v248, s9, v5
s_lshl_b32 s9, s3, 2
v_mov_b32 v250, s9
v_exp_f32 v146, v146
v_exp_f32 v147, v147
v_mfma_f32_32x32x16_bf16 v[168:183], v[64:67], v[136:139], v[168:183]
v_exp_f32 v148, v148
v_exp_f32 v149, v149
v_exp_f32 v150, v150
v_exp_f32 v151, v151
s_waitcnt vmcnt(4)
v_mfma_f32_32x32x16_bf16 v[200:215], v[224:227], v[228:231], v[200:215]
v_cvt_pk_bf16_f32 v140, v144, v145
v_cvt_pk_bf16_f32 v141, v146, v147
v_cvt_pk_bf16_f32 v142, v148, v149
v_cvt_pk_bf16_f32 v143, v150, v151
v_exp_f32 v120, v120
v_exp_f32 v121, v121
v_mfma_f32_32x32x16_bf16 v[168:183], v[68:71], v[140:143], v[168:183]
v_exp_f32 v122, v122
v_exp_f32 v123, v123
v_exp_f32 v124, v124
v_exp_f32 v125, v125
v_mfma_f32_32x32x8_bf16 v[136:151], v[18:19], v[198:199], 0
v_exp_f32 v126, v126
v_exp_f32 v127, v127
v_cvt_pk_bf16_f32 v120, v120, v121
v_cvt_pk_bf16_f32 v121, v122, v123
v_cvt_pk_bf16_f32 v122, v124, v125
v_cvt_pk_bf16_f32 v123, v126, v127
v_mfma_f32_32x32x16_bf16 v[136:151], v[36:39], v[192:195], v[136:151]
v_exp_f32 v128, v128
v_exp_f32 v129, v129
v_exp_f32 v130, v130
v_exp_f32 v131, v131
v_mfma_f32_32x32x16_bf16 v[168:183], v[72:75], v[120:123], v[168:183]
v_exp_f32 v132, v132
v_exp_f32 v133, v133
v_exp_f32 v134, v134
v_exp_f32 v135, v135
s_waitcnt vmcnt(2)
v_mfma_f32_32x32x16_bf16 v[200:215], v[232:235], v[236:239], v[200:215]
v_cvt_pk_bf16_f32 v124, v128, v129
v_cvt_pk_bf16_f32 v125, v130, v131
v_cvt_pk_bf16_f32 v126, v132, v133
v_cvt_pk_bf16_f32 v127, v134, v135
s_add_u32 s8, s2, 192
s_and_b32 s8, s8, 255
s_cmp_lt_u32 s8, 192
s_cselect_b32 s101, 1, 0
s_cmp_lt_u32 s3, 4
s_cselect_b32 s101, s101, 0
s_add_u32 s96, s48, 16125952
s_addc_u32 s97, s49, 0
s_and_b32 s97, s97, 0xffff
s_mov_b32 s98, 663552
s_mov_b32 s99, 0x20000
s_lshl_b32 s92, s3, 7
v_xor_b32 v13, s92, v5
s_lshr_b32 s92, s8, 5
s_mul_i32 s92, s92, 110592
s_mul_i32 s93, s3, 9216
s_add_u32 s92, s92, s93
s_add_u32 s93, s92, 36864
s_add_u32 s94, s93, 36864
v_exp_f32 v136, v136
v_exp_f32 v137, v137
v_mfma_f32_32x32x16_bf16 v[168:183], v[76:79], v[124:127], v[168:183]
v_exp_f32 v138, v138
v_exp_f32 v139, v139
v_exp_f32 v140, v140
v_exp_f32 v141, v141
v_mfma_f32_32x32x8_bf16 v[120:135], v[20:21], v[196:197], 0
v_exp_f32 v142, v142
v_exp_f32 v143, v143
v_cvt_pk_bf16_f32 v136, v136, v137
v_cvt_pk_bf16_f32 v137, v138, v139
v_cvt_pk_bf16_f32 v138, v140, v141
v_cvt_pk_bf16_f32 v139, v142, v143
v_mfma_f32_32x32x16_bf16 v[120:135], v[40:43], v[192:195], v[120:135]
v_exp_f32 v144, v144
v_exp_f32 v145, v145
v_exp_f32 v146, v146
v_exp_f32 v147, v147
v_mfma_f32_32x32x16_bf16 v[168:183], v[80:83], v[136:139], v[168:183]
v_exp_f32 v148, v148
v_exp_f32 v149, v149
v_exp_f32 v150, v150
v_exp_f32 v151, v151
s_waitcnt vmcnt(0)
v_mfma_f32_32x32x16_bf16 v[200:215], v[240:243], v[244:247], v[200:215]
v_cvt_pk_bf16_f32 v140, v144, v145
v_cvt_pk_bf16_f32 v141, v146, v147
v_cvt_pk_bf16_f32 v142, v148, v149
v_cvt_pk_bf16_f32 v143, v150, v151
s_cmp_eq_u32 s101, 0
s_cbranch_scc1 k2_wp3
s_add_u32 s95, s94, 0
buffer_load_dwordx4 v[24:27], v13, s[96:99], s95 offen
s_add_u32 s95, s92, 1024
buffer_load_dwordx4 v[28:31], v13, s[96:99], s95 offen
s_add_u32 s95, s93, 1024
buffer_load_dwordx4 v[32:35], v13, s[96:99], s95 offen
s_add_u32 s95, s94, 1024
buffer_load_dwordx4 v[36:39], v13, s[96:99], s95 offen
s_add_u32 s95, s92, 2048
buffer_load_dwordx4 v[40:43], v13, s[96:99], s95 offen
s_add_u32 s95, s93, 3072
buffer_load_dwordx4 v[56:59], v13, s[96:99], s95 offen
s_add_u32 s95, s94, 3072
buffer_load_dwordx4 v[60:63], v13, s[96:99], s95 offen
s_add_u32 s95, s92, 4096
buffer_load_dwordx4 v[64:67], v13, s[96:99], s95 offen
s_add_u32 s95, s93, 4096
buffer_load_dwordx4 v[68:71], v13, s[96:99], s95 offen
s_add_u32 s95, s94, 4096
buffer_load_dwordx4 v[72:75], v13, s[96:99], s95 offen
s_add_u32 s95, s92, 5120
buffer_load_dwordx4 v[76:79], v13, s[96:99], s95 offen
k2_wp3:
v_exp_f32 v120, v120
v_exp_f32 v121, v121
v_mfma_f32_32x32x16_bf16 v[168:183], v[84:87], v[140:143], v[168:183]
v_exp_f32 v122, v122
v_exp_f32 v123, v123
v_exp_f32 v124, v124
v_exp_f32 v125, v125
v_mfma_f32_32x32x8_bf16 v[136:151], v[20:21], v[198:199], 0
v_exp_f32 v126, v126
v_exp_f32 v127, v127
v_cvt_pk_bf16_f32 v120, v120, v121
v_cvt_pk_bf16_f32 v121, v122, v123
v_cvt_pk_bf16_f32 v122, v124, v125
v_cvt_pk_bf16_f32 v123, v126, v127
v_mfma_f32_32x32x16_bf16 v[136:151], v[44:47], v[192:195], v[136:151]
v_exp_f32 v128, v128
v_exp_f32 v129, v129
ds_write_b128 v248, v[208:211]
ds_write_b128 v248, v[212:215] offset:1024
v_xor_b32 v251, 16, v250
s_lshl_b32 s9, s3, 11
s_xor_b32 s9, s9, 8192
s_add_u32 s9, s9, 146832
v_add_u32 v248, s9, v5
ds_read_b32 v12, v10 offset:512
v_exp_f32 v130, v130
v_exp_f32 v131, v131
v_exp_f32 v132, v132
v_exp_f32 v133, v133
v_mfma_f32_32x32x16_bf16 v[168:183], v[88:91], v[120:123], v[168:183]
v_exp_f32 v134, v134
v_exp_f32 v135, v135
v_cvt_pk_bf16_f32 v124, v128, v129
v_cvt_pk_bf16_f32 v125, v130, v131
v_cvt_pk_bf16_f32 v126, v132, v133
v_cvt_pk_bf16_f32 v127, v134, v135
s_cmp_eq_u32 s101, 0
s_cbranch_scc1 k2_wp4
s_add_u32 s95, s93, 2048
buffer_load_dwordx4 v[44:47], v13, s[96:99], s95 offen
s_add_u32 s95, s93, 5120
buffer_load_dwordx4 v[80:83], v13, s[96:99], s95 offen
s_add_u32 s95, s94, 5120
buffer_load_dwordx4 v[84:87], v13, s[96:99], s95 offen
k2_wp4:
v_exp_f32 v136, v136
v_exp_f32 v137, v137
v_mfma_f32_32x32x16_bf16 v[168:183], v[92:95], v[124:127], v[168:183]
v_exp_f32 v138, v138
v_exp_f32 v139, v139
v_exp_f32 v140, v140
v_exp_f32 v141, v141
v_mfma_f32_32x32x8_bf16 v[120:135], v[22:23], v[196:197], 0
v_exp_f32 v142, v142
v_exp_f32 v143, v143
v_cvt_pk_bf16_f32 v136, v136, v137
v_cvt_pk_bf16_f32 v137, v138, v139
v_cvt_pk_bf16_f32 v138, v140, v141
v_cvt_pk_bf16_f32 v139, v142, v143
v_mfma_f32_32x32x16_bf16 v[120:135], v[48:51], v[192:195], v[120:135]
v_exp_f32 v144, v144
v_exp_f32 v145, v145
k2_pollr7:
s_waitcnt lgkmcnt(0)
v_readfirstlane_b32 s9, v12
s_nop 0
s_cmp_lg_u32 s9, 0
s_cbranch_scc1 k2_okr7
s_sleep 2
ds_read_b32 v12, v10 offset:512
s_branch k2_pollr7
k2_okr7:
ds_write_b32 v250, v11
ds_read_b128 v[152:155], v9 offset:0
ds_read_b128 v[156:159], v9 offset:1024
ds_read_b64 v[160:161], v10 offset:0
v_exp_f32 v146, v146
v_exp_f32 v147, v147
v_exp_f32 v148, v148
v_exp_f32 v149, v149
v_mfma_f32_32x32x16_bf16 v[168:183], v[96:99], v[136:139], v[168:183]
v_exp_f32 v150, v150
v_exp_f32 v151, v151
v_cvt_pk_bf16_f32 v140, v144, v145
v_cvt_pk_bf16_f32 v141, v146, v147
v_cvt_pk_bf16_f32 v142, v148, v149
v_cvt_pk_bf16_f32 v143, v150, v151
s_cmp_eq_u32 s101, 0
s_cbranch_scc1 k2_wp5
s_add_u32 s95, s94, 2048
buffer_load_dwordx4 v[48:51], v13, s[96:99], s95 offen
s_add_u32 s95, s92, 6144
buffer_load_dwordx4 v[88:91], v13, s[96:99], s95 offen
s_add_u32 s95, s93, 6144
buffer_load_dwordx4 v[92:95], v13, s[96:99], s95 offen
k2_wp5:
v_exp_f32 v120, v120
v_exp_f32 v121, v121
v_mfma_f32_32x32x16_bf16 v[168:183], v[100:103], v[140:143], v[168:183]
v_exp_f32 v122, v122
v_exp_f32 v123, v123
v_exp_f32 v124, v124
v_exp_f32 v125, v125
v_mfma_f32_32x32x8_bf16 v[136:151], v[22:23], v[198:199], 0
v_exp_f32 v126, v126
v_exp_f32 v127, v127
v_cvt_pk_bf16_f32 v120, v120, v121
v_cvt_pk_bf16_f32 v121, v122, v123
v_cvt_pk_bf16_f32 v122, v124, v125
v_cvt_pk_bf16_f32 v123, v126, v127
v_mfma_f32_32x32x16_bf16 v[136:151], v[52:55], v[192:195], v[136:151]
v_exp_f32 v128, v128
v_exp_f32 v129, v129
v_exp_f32 v130, v130
v_exp_f32 v131, v131
v_exp_f32 v132, v132
v_exp_f32 v133, v133
v_mfma_f32_32x32x16_bf16 v[168:183], v[104:107], v[120:123], v[168:183]
v_exp_f32 v134, v134
v_exp_f32 v135, v135
v_cvt_pk_bf16_f32 v124, v128, v129
v_cvt_pk_bf16_f32 v125, v130, v131
v_cvt_pk_bf16_f32 v126, v132, v133
v_cvt_pk_bf16_f32 v127, v134, v135
s_cmp_eq_u32 s101, 0
s_cbranch_scc1 k2_wp6
s_add_u32 s95, s92, 3072
buffer_load_dwordx4 v[52:55], v13, s[96:99], s95 offen
s_add_u32 s95, s94, 6144
buffer_load_dwordx4 v[96:99], v13, s[96:99], s95 offen
s_add_u32 s95, s92, 7168
buffer_load_dwordx4 v[100:103], v13, s[96:99], s95 offen
s_add_u32 s95, s92, 0
buffer_load_dwordx4 v[16:19], v13, s[96:99], s95 offen
s_add_u32 s95, s93, 0
buffer_load_dwordx4 v[20:23], v13, s[96:99], s95 offen
k2_wp6:
v_exp_f32 v136, v136
v_exp_f32 v137, v137
v_mfma_f32_32x32x16_bf16 v[168:183], v[108:111], v[124:127], v[168:183]
v_exp_f32 v138, v138
v_exp_f32 v139, v139
v_exp_f32 v140, v140
v_exp_f32 v141, v141
v_exp_f32 v142, v142
v_exp_f32 v143, v143
v_cvt_pk_bf16_f32 v136, v136, v137
v_cvt_pk_bf16_f32 v137, v138, v139
v_cvt_pk_bf16_f32 v138, v140, v141
v_cvt_pk_bf16_f32 v139, v142, v143
v_exp_f32 v144, v144
v_exp_f32 v145, v145
ds_read_b32 v250, v251
v_exp_f32 v146, v146
v_exp_f32 v147, v147
v_exp_f32 v148, v148
v_exp_f32 v149, v149
s_waitcnt lgkmcnt(0)
v_mfma_f32_32x32x16_bf16 v[168:183], v[112:115], v[136:139], v[168:183]
v_exp_f32 v150, v150
v_exp_f32 v151, v151
v_cvt_pk_bf16_f32 v140, v144, v145
v_cvt_pk_bf16_f32 v141, v146, v147
v_cvt_pk_bf16_f32 v142, v148, v149
v_cvt_pk_bf16_f32 v143, v150, v151
s_cmp_eq_u32 s101, 0
s_cbranch_scc1 k2_wp7
s_add_u32 s95, s93, 7168
buffer_load_dwordx4 v[104:107], v13, s[96:99], s95 offen
s_add_u32 s95, s94, 7168
buffer_load_dwordx4 v[108:111], v13, s[96:99], s95 offen
k2_wp7:
v_mfma_f32_32x32x16_bf16 v[168:183], v[116:119], v[140:143], v[168:183]
s_add_u32 s8, s2, 192
s_and_b32 s8, s8, 255
s_mov_b32 s100, 0
s_cmp_eq_u32 s101, 0
s_cbranch_scc1 k2_wp8
s_add_u32 s95, s92, 8192
buffer_load_dwordx4 v[112:115], v13, s[96:99], s95 offen
s_add_u32 s95, s93, 8192
buffer_load_dwordx4 v[116:119], v13, s[96:99], s95 offen
s_add_u32 s95, s94, 8192
buffer_load_dwordx4 v[120:123], v13, s[96:99], s95 offen
k2_wp8:
k2_xpoll:
s_waitcnt lgkmcnt(0)
v_readfirstlane_b32 s9, v250
s_nop 0
s_cmp_lg_u32 s9, 0
s_cbranch_scc1 k2_xok
s_sleep 2
ds_read_b32 v250, v251
s_branch k2_xpoll
k2_xok:
ds_read_b128 v[224:227], v248
ds_read_b128 v[228:231], v248 offset:1024
s_add_u32 s10, s3, 7
s_and_b32 s10, s10, 7
s_lshr_b32 s9, s2, 2
s_mul_i32 s9, s9, 36864
s_and_b32 s11, s2, 3
s_lshl_b32 s11, s11, 7
s_add_u32 s9, s9, s11
s_lshl_b32 s11, s10, 9
s_add_u32 s11, s11, s9
s_add_u32 s11, s11, 32768
s_lshl_b32 s10, s10, 12
s_add_u32 s9, s9, s10
v_bfe_u32 v2, v0, 2, 3
v_lshlrev_b32 v2, 4, v2
v_and_b32 v1, 3, v0
v_lshrrev_b32 v4, 5, v0
v_lshl_add_u32 v3, v1, 2, v2
v_lshl_add_u32 v3, v4, 28, v3
v_lshl_add_u32 v2, v1, 10, v2
v_lshl_add_u32 v2, v4, 9, v2
v_pk_add_f32 v[168:169], v[168:169], v[152:153]
v_pk_add_f32 v[170:171], v[170:171], v[154:155]
v_pk_add_f32 v[172:173], v[172:173], v[156:157]
v_pk_add_f32 v[174:175], v[174:175], v[158:159]
v_pk_add_f32 v[176:177], v[176:177], v[160:161]
v_mov_b32 v14, v176
v_mov_b32 v15, v176
s_nop 1
v_permlane32_swap_b32 v14, v15
v_subrev_u32 v14, 562036736, v15
v_cmp_lt_u32 vcc, 1006632960, v14
s_waitcnt lgkmcnt(0)
v_pk_add_f32 v[200:201], v[200:201], v[224:225]
v_pk_add_f32 v[202:203], v[202:203], v[226:227]
v_pk_add_f32 v[204:205], v[204:205], v[228:229]
v_pk_add_f32 v[206:207], v[206:207], v[230:231]
buffer_store_dwordx4 v[200:203], v249, s[72:75], s70 offen offset:0
buffer_store_dwordx4 v[204:207], v249, s[72:75], s70 offen offset:32
s_cbranch_vccnz k2_slow
k2_fin:
v_rcp_f32 v14, v15
s_nop 0
v_pk_mul_f32 v[168:169], v[168:169], v[14:15] op_sel_hi:[1,0]
v_pk_mul_f32 v[170:171], v[170:171], v[14:15] op_sel_hi:[1,0]
v_pk_mul_f32 v[172:173], v[172:173], v[14:15] op_sel_hi:[1,0]
v_pk_mul_f32 v[174:175], v[174:175], v[14:15] op_sel_hi:[1,0]
v_pk_mul_f32 v[176:177], v[176:177], v[14:15] op_sel_hi:[1,0]
v_cvt_pk_bf16_f32 v168, v168, v169
v_cvt_pk_bf16_f32 v169, v170, v171
v_cvt_pk_bf16_f32 v170, v172, v173
v_cvt_pk_bf16_f32 v171, v174, v175
v_cvt_pk_bf16_f32 v172, v176, v177
buffer_store_dwordx4 v[168:171], v2, s[64:67], s9 offen sc1
buffer_store_dword v172, v3, s[64:67], s11 offen sc1
s_and_b32 s6, s3, 3
v_lshlrev_b32 v2, 4, v0
s_cmp_ge_u32 s8, 192
s_cbranch_scc1 k3_ssm
s_add_u32 s68, s48, 16109568
s_addc_u32 s69, s49, 0
s_and_b32 s69, s69, 0xffff
s_mov_b32 s70, 16384
s_mov_b32 s71, 0x20000
s_lshl_b32 s60, s2, 3
s_add_u32 s60, s60, s3
s_lshl_b32 s60, s60, 2
s_add_u32 s60, s60, 8192
v_mov_b32 v10, 1
s_waitcnt vmcnt(0)
s_mov_b64 exec, 1
buffer_store_dword v10, v2, s[68:71], s60 offen sc1
s_mov_b64 exec, -1
s_cmp_eq_u32 s100, 0
s_cbranch_scc1 k3_wok
s_cmp_ge_u32 s8, 192
s_cbranch_scc1 k3_w2
s_cmp_ge_u32 s3, 4
s_cbranch_scc1 k3_w2
s_add_u32 s96, s48, 16125952
s_addc_u32 s97, s49, 0
s_and_b32 s97, s97, 0xffff
s_mov_b32 s98, 663552
s_mov_b32 s99, 0x20000
s_lshl_b32 s92, s3, 7
v_xor_b32 v12, s92, v5
s_lshr_b32 s92, s8, 5
s_mul_i32 s92, s92, 110592
s_mul_i32 s93, s3, 9216
s_add_u32 s92, s92, s93
s_add_u32 s93, s92, 36864
s_add_u32 s94, s93, 36864
buffer_load_dwordx4 v[16:19], v12, s[96:99], s92 offen offset:0
buffer_load_dwordx4 v[20:23], v12, s[96:99], s93 offen offset:0
buffer_load_dwordx4 v[24:27], v12, s[96:99], s94 offen offset:0
buffer_load_dwordx4 v[28:31], v12, s[96:99], s92 offen offset:1024
buffer_load_dwordx4 v[32:35], v12, s[96:99], s93 offen offset:1024
buffer_load_dwordx4 v[36:39], v12, s[96:99], s94 offen offset:1024
buffer_load_dwordx4 v[40:43], v12, s[96:99], s92 offen offset:2048
buffer_load_dwordx4 v[44:47], v12, s[96:99], s93 offen offset:2048
buffer_load_dwordx4 v[48:51], v12, s[96:99], s94 offen offset:2048
buffer_load_dwordx4 v[52:55], v12, s[96:99], s92 offen offset:3072
buffer_load_dwordx4 v[56:59], v12, s[96:99], s93 offen offset:3072
buffer_load_dwordx4 v[60:63], v12, s[96:99], s94 offen offset:3072
s_add_u32 s92, s92, 4096
s_add_u32 s93, s93, 4096
s_add_u32 s94, s94, 4096
buffer_load_dwordx4 v[64:67], v12, s[96:99], s92 offen offset:0
buffer_load_dwordx4 v[68:71], v12, s[96:99], s93 offen offset:0
buffer_load_dwordx4 v[72:75], v12, s[96:99], s94 offen offset:0
buffer_load_dwordx4 v[76:79], v12, s[96:99], s92 offen offset:1024
buffer_load_dwordx4 v[80:83], v12, s[96:99], s93 offen offset:1024
buffer_load_dwordx4 v[84:87], v12, s[96:99], s94 offen offset:1024
buffer_load_dwordx4 v[88:91], v12, s[96:99], s92 offen offset:2048
buffer_load_dwordx4 v[92:95], v12, s[96:99], s93 offen offset:2048
buffer_load_dwordx4 v[96:99], v12, s[96:99], s94 offen offset:2048
buffer_load_dwordx4 v[100:103], v12, s[96:99], s92 offen offset:3072
buffer_load_dwordx4 v[104:107], v12, s[96:99], s93 offen offset:3072
buffer_load_dwordx4 v[108:111], v12, s[96:99], s94 offen offset:3072
s_add_u32 s92, s92, 4096
s_add_u32 s93, s93, 4096
s_add_u32 s94, s94, 4096
buffer_load_dwordx4 v[112:115], v12, s[96:99], s92 offen offset:0
buffer_load_dwordx4 v[116:119], v12, s[96:99], s93 offen offset:0
buffer_load_dwordx4 v[120:123], v12, s[96:99], s94 offen offset:0
k3_w2:
k3_wok:
s_and_b32 s4, s8, 31
s_lshl_b32 s7, s4, 8
s_add_u32 s7, s7, 8192
s_lshl_b32 s4, s4, 1
s_lshr_b32 s5, s3, 2
s_add_u32 s4, s4, s5
s_lshr_b32 s5, s8, 5
s_mul_i32 s60, s6, 9216
s_mul_i32 s54, s4, 36864
s_add_u32 s54, s54, s60
s_add_u32 s64, s48, 2359296
s_addc_u32 s65, s49, 0
s_and_b32 s65, s65, 0xffff
s_mov_b32 s66, 2359296
s_mov_b32 s67, 0x20000
s_mov_b32 s72, s44
s_and_b32 s73, s45, 0xffff
s_mov_b32 s74, 9437184
s_mov_b32 s75, 0x20000
v_and_b32 v12, 31, v0
v_mul_u32_u24 v12, 4608, v12
v_lshrrev_b32 v13, 5, v0
v_lshl_add_u32 v12, v13, 4, v12
s_mul_i32 s58, s4, 147456
s_mul_i32 s59, s5, 384
s_add_u32 s58, s58, s59
s_lshl_b32 s59, s6, 5
s_add_u32 s58, s58, s59
s_add_u32 s58, s58, 2304
s_lshl_b32 s60, s3, 14
v_add_u32 v4, s60, v2
v_xor_b32 v5, 16384, v4
v_xor_b32 v6, 32768, v4
v_xor_b32 v7, 49152, v4
v_lshl_add_u32 v11, v0, 2, s7
s_mul_i32 s60, s6, 27648
v_add_u32 v8, s60, v2
s_barrier
s_cmp_ge_u32 s3, 4
s_cbranch_scc1 k3_wrd
s_waitcnt vmcnt(0)
ds_write_b128 v8, v[16:19] offset:0
ds_write_b128 v8, v[20:23] offset:1024
ds_write_b128 v8, v[24:27] offset:2048
ds_write_b128 v8, v[28:31] offset:3072
ds_write_b128 v8, v[32:35] offset:4096
ds_write_b128 v8, v[36:39] offset:5120
ds_write_b128 v8, v[40:43] offset:6144
ds_write_b128 v8, v[44:47] offset:7168
ds_write_b128 v8, v[48:51] offset:8192
ds_write_b128 v8, v[52:55] offset:9216
ds_write_b128 v8, v[56:59] offset:10240
ds_write_b128 v8, v[60:63] offset:11264
ds_write_b128 v8, v[64:67] offset:12288
ds_write_b128 v8, v[68:71] offset:13312
ds_write_b128 v8, v[72:75] offset:14336
ds_write_b128 v8, v[76:79] offset:15360
ds_write_b128 v8, v[80:83] offset:16384
ds_write_b128 v8, v[84:87] offset:17408
ds_write_b128 v8, v[88:91] offset:18432
ds_write_b128 v8, v[92:95] offset:19456
ds_write_b128 v8, v[96:99] offset:20480
ds_write_b128 v8, v[100:103] offset:21504
ds_write_b128 v8, v[104:107] offset:22528
ds_write_b128 v8, v[108:111] offset:23552
ds_write_b128 v8, v[112:115] offset:24576
ds_write_b128 v8, v[116:119] offset:25600
ds_write_b128 v8, v[120:123] offset:26624
s_waitcnt lgkmcnt(0)
s_barrier
s_cmp_lg_u32 s3, 0
s_cbranch_scc1 k3_o_ok
s_mov_b32 s71, 0x20000
s_mov_b32 s61, 0
k3_o_p:
buffer_load_dword v10, v11, s[68:71], 0 offen sc1
s_waitcnt vmcnt(0)
v_cmp_ne_u32 vcc, 1, v10
s_cbranch_vccz k3_o_ok
s_add_u32 s61, s61, 1
s_cmp_gt_u32 s61, 0x40000
s_cbranch_scc1 k3_o_ok
s_sleep 12
s_branch k3_o_p
k3_wrd:
s_barrier
ds_read_b128 v[16:19], v8 offset:0
ds_read_b128 v[20:23], v8 offset:1024
ds_read_b128 v[24:27], v8 offset:2048
ds_read_b128 v[28:31], v8 offset:3072
ds_read_b128 v[32:35], v8 offset:4096
ds_read_b128 v[36:39], v8 offset:5120
ds_read_b128 v[40:43], v8 offset:6144
ds_read_b128 v[44:47], v8 offset:7168
ds_read_b128 v[48:51], v8 offset:8192
ds_read_b128 v[52:55], v8 offset:9216
ds_read_b128 v[56:59], v8 offset:10240
ds_read_b128 v[60:63], v8 offset:11264
ds_read_b128 v[64:67], v8 offset:12288
ds_read_b128 v[68:71], v8 offset:13312
ds_read_b128 v[72:75], v8 offset:14336
ds_read_b128 v[76:79], v8 offset:15360
ds_read_b128 v[80:83], v8 offset:16384
ds_read_b128 v[84:87], v8 offset:17408
ds_read_b128 v[88:91], v8 offset:18432
ds_read_b128 v[92:95], v8 offset:19456
ds_read_b128 v[96:99], v8 offset:20480
ds_read_b128 v[100:103], v8 offset:21504
ds_read_b128 v[104:107], v8 offset:22528
ds_read_b128 v[108:111], v8 offset:23552
ds_read_b128 v[112:115], v8 offset:24576
ds_read_b128 v[116:119], v8 offset:25600
ds_read_b128 v[120:123], v8 offset:26624
s_waitcnt lgkmcnt(0)
k3_o_ok:
s_barrier
buffer_load_dwordx4 v[124:127], v2, s[64:67], s54 offen offset:0 sc1
buffer_load_dwordx4 v[128:131], v2, s[64:67], s54 offen offset:1024 sc1
buffer_load_dwordx4 v[132:135], v2, s[64:67], s54 offen offset:2048 sc1
buffer_load_dwordx4 v[136:139], v2, s[64:67], s54 offen offset:3072 sc1
s_add_u32 s54, s54, 4096
buffer_load_dwordx4 v[140:143], v2, s[64:67], s54 offen offset:0 sc1
buffer_load_dwordx4 v[144:147], v2, s[64:67], s54 offen offset:1024 sc1
buffer_load_dwordx4 v[148:151], v2, s[64:67], s54 offen offset:2048 sc1
buffer_load_dwordx4 v[152:155], v2, s[64:67], s54 offen offset:3072 sc1
s_add_u32 s54, s54, 4096
buffer_load_dwordx4 v[156:159], v2, s[64:67], s54 offen offset:0 sc1
s_waitcnt vmcnt(8)
v_mfma_f32_32x32x16_bf16 v[160:175], v[16:19], v[124:127], 0
v_mfma_f32_32x32x16_bf16 v[176:191], v[20:23], v[124:127], 0
v_mfma_f32_32x32x16_bf16 v[192:207], v[24:27], v[124:127], 0
s_waitcnt vmcnt(7)
v_mfma_f32_32x32x16_bf16 v[160:175], v[28:31], v[128:131], v[160:175]
v_mfma_f32_32x32x16_bf16 v[176:191], v[32:35], v[128:131], v[176:191]
v_mfma_f32_32x32x16_bf16 v[192:207], v[36:39], v[128:131], v[192:207]
s_waitcnt vmcnt(6)
v_mfma_f32_32x32x16_bf16 v[160:175], v[40:43], v[132:135], v[160:175]
v_mfma_f32_32x32x16_bf16 v[176:191], v[44:47], v[132:135], v[176:191]
v_mfma_f32_32x32x16_bf16 v[192:207], v[48:51], v[132:135], v[192:207]
s_waitcnt vmcnt(5)
v_mfma_f32_32x32x16_bf16 v[160:175], v[52:55], v[136:139], v[160:175]
v_mfma_f32_32x32x16_bf16 v[176:191], v[56:59], v[136:139], v[176:191]
v_mfma_f32_32x32x16_bf16 v[192:207], v[60:63], v[136:139], v[192:207]
s_waitcnt vmcnt(4)
v_mfma_f32_32x32x16_bf16 v[160:175], v[64:67], v[140:143], v[160:175]
v_mfma_f32_32x32x16_bf16 v[176:191], v[68:71], v[140:143], v[176:191]
v_mfma_f32_32x32x16_bf16 v[192:207], v[72:75], v[140:143], v[192:207]
s_waitcnt vmcnt(3)
v_mfma_f32_32x32x16_bf16 v[160:175], v[76:79], v[144:147], v[160:175]
v_mfma_f32_32x32x16_bf16 v[176:191], v[80:83], v[144:147], v[176:191]
v_mfma_f32_32x32x16_bf16 v[192:207], v[84:87], v[144:147], v[192:207]
s_waitcnt vmcnt(2)
v_mfma_f32_32x32x16_bf16 v[160:175], v[88:91], v[148:151], v[160:175]
v_mfma_f32_32x32x16_bf16 v[176:191], v[92:95], v[148:151], v[176:191]
v_mfma_f32_32x32x16_bf16 v[192:207], v[96:99], v[148:151], v[192:207]
s_waitcnt vmcnt(1)
v_mfma_f32_32x32x16_bf16 v[160:175], v[100:103], v[152:155], v[160:175]
v_mfma_f32_32x32x16_bf16 v[176:191], v[104:107], v[152:155], v[176:191]
v_mfma_f32_32x32x16_bf16 v[192:207], v[108:111], v[152:155], v[192:207]
s_waitcnt vmcnt(0)
v_mfma_f32_32x32x16_bf16 v[160:175], v[112:115], v[156:159], v[160:175]
v_mfma_f32_32x32x16_bf16 v[176:191], v[116:119], v[156:159], v[176:191]
v_mfma_f32_32x32x16_bf16 v[192:207], v[120:123], v[156:159], v[192:207]
s_nop 9
ds_write_b128 v5, v[164:167] offset:0
ds_write_b128 v6, v[168:171] offset:3072
ds_write_b128 v7, v[172:175] offset:6144
ds_write_b128 v5, v[180:183] offset:1024
ds_write_b128 v6, v[184:187] offset:4096
ds_write_b128 v7, v[188:191] offset:7168
ds_write_b128 v5, v[196:199] offset:2048
ds_write_b128 v6, v[200:203] offset:5120
ds_write_b128 v7, v[204:207] offset:8192
s_waitcnt lgkmcnt(0)
s_barrier
ds_read_b128 v[16:19], v4 offset:0
ds_read_b128 v[20:23], v4 offset:3072
ds_read_b128 v[24:27], v4 offset:6144
ds_read_b128 v[28:31], v4 offset:1024
ds_read_b128 v[32:35], v4 offset:4096
ds_read_b128 v[36:39], v4 offset:7168
ds_read_b128 v[40:43], v4 offset:2048
ds_read_b128 v[44:47], v4 offset:5120
ds_read_b128 v[48:51], v4 offset:8192
s_waitcnt lgkmcnt(8)
v_pk_add_f32 v[160:161], v[160:161], v[16:17]
v_pk_add_f32 v[162:163], v[162:163], v[18:19]
s_waitcnt lgkmcnt(7)
v_pk_add_f32 v[160:161], v[160:161], v[20:21]
v_pk_add_f32 v[162:163], v[162:163], v[22:23]
s_waitcnt lgkmcnt(6)
v_pk_add_f32 v[160:161], v[160:161], v[24:25]
v_pk_add_f32 v[162:163], v[162:163], v[26:27]
buffer_store_dwordx4 v[160:163], v12, s[72:75], s58 offen offset:0
s_waitcnt lgkmcnt(5)
v_pk_add_f32 v[176:177], v[176:177], v[28:29]
v_pk_add_f32 v[178:179], v[178:179], v[30:31]
s_waitcnt lgkmcnt(4)
v_pk_add_f32 v[176:177], v[176:177], v[32:33]
v_pk_add_f32 v[178:179], v[178:179], v[34:35]
s_waitcnt lgkmcnt(3)
v_pk_add_f32 v[176:177], v[176:177], v[36:37]
v_pk_add_f32 v[178:179], v[178:179], v[38:39]
buffer_store_dwordx4 v[176:179], v12, s[72:75], s58 offen offset:128
s_waitcnt lgkmcnt(2)
v_pk_add_f32 v[192:193], v[192:193], v[40:41]
v_pk_add_f32 v[194:195], v[194:195], v[42:43]
s_waitcnt lgkmcnt(1)
v_pk_add_f32 v[192:193], v[192:193], v[44:45]
v_pk_add_f32 v[194:195], v[194:195], v[46:47]
s_waitcnt lgkmcnt(0)
v_pk_add_f32 v[192:193], v[192:193], v[48:49]
v_pk_add_f32 v[194:195], v[194:195], v[50:51]
buffer_store_dwordx4 v[192:195], v12, s[72:75], s58 offen offset:256
s_endpgm
k3_ssm:
s_sub_u32 s4, s8, 192
s_mul_i32 s54, s3, 9216
s_mul_i32 s55, s4, 73728
s_add_u32 s55, s55, s54
s_add_u32 s55, s55, 1327104
s_add_u32 s54, s54, 1179648
s_add_u32 s56, s54, 73728
s_lshl_b32 s7, s4, 7
v_min_u32 v11, 17, v0
v_lshl_add_u32 v11, v11, 2, s7
s_add_u32 s68, s48, 16109568
s_addc_u32 s69, s49, 0
s_and_b32 s69, s69, 0xffff
s_mov_b32 s70, 16384
s_mov_b32 s71, 0x20000
s_mov_b32 s71, 0x20000
s_mov_b32 s61, 0
k3_h_p:
buffer_load_dword v10, v11, s[68:71], 0 offen sc1
s_waitcnt vmcnt(0)
v_cmp_ne_u32 vcc, 1, v10
s_cbranch_vccz k3_h_ok
s_add_u32 s61, s61, 1
s_cmp_gt_u32 s61, 0x40000
s_cbranch_scc1 k3_h_ok
s_sleep 12
s_branch k3_h_p
k3_h_ok:
s_add_u32 s68, s48, 16109568
s_addc_u32 s69, s49, 0
s_and_b32 s69, s69, 0xffff
s_mov_b32 s70, 16384
s_mov_b32 s71, 0x20000
s_lshl_b32 s60, s2, 3
s_add_u32 s60, s60, s3
s_lshl_b32 s60, s60, 2
s_add_u32 s60, s60, 8192
v_mov_b32 v10, 1
s_waitcnt vmcnt(0)
s_mov_b64 exec, 1
buffer_store_dword v10, v2, s[68:71], s60 offen sc1
s_mov_b64 exec, -1
s_barrier
s_add_u32 s64, s48, 10063872
s_addc_u32 s65, s49, 0
s_and_b32 s65, s65, 0xffff
s_mov_b32 s66, 6045696
s_mov_b32 s67, 0x20000
buffer_load_dwordx4 v[48:51], v2, s[64:67], s55 offen offset:0 sc1
buffer_load_dwordx4 v[52:55], v2, s[64:67], s54 offen offset:0
buffer_load_dwordx4 v[56:59], v2, s[64:67], s56 offen offset:0
buffer_load_dwordx4 v[60:63], v2, s[64:67], s55 offen offset:1024 sc1
buffer_load_dwordx4 v[64:67], v2, s[64:67], s54 offen offset:1024
buffer_load_dwordx4 v[68:71], v2, s[64:67], s56 offen offset:1024
buffer_load_dwordx4 v[72:75], v2, s[64:67], s55 offen offset:2048 sc1
buffer_load_dwordx4 v[76:79], v2, s[64:67], s54 offen offset:2048
buffer_load_dwordx4 v[80:83], v2, s[64:67], s56 offen offset:2048
buffer_load_dwordx4 v[84:87], v2, s[64:67], s55 offen offset:3072 sc1
buffer_load_dwordx4 v[88:91], v2, s[64:67], s54 offen offset:3072
buffer_load_dwordx4 v[92:95], v2, s[64:67], s56 offen offset:3072
s_add_u32 s54, s54, 4096
s_add_u32 s55, s55, 4096
s_add_u32 s56, s56, 4096
buffer_load_dwordx4 v[96:99], v2, s[64:67], s55 offen offset:0 sc1
buffer_load_dwordx4 v[100:103], v2, s[64:67], s54 offen offset:0
buffer_load_dwordx4 v[104:107], v2, s[64:67], s56 offen offset:0
buffer_load_dwordx4 v[108:111], v2, s[64:67], s55 offen offset:1024 sc1
buffer_load_dwordx4 v[112:115], v2, s[64:67], s54 offen offset:1024
buffer_load_dwordx4 v[116:119], v2, s[64:67], s56 offen offset:1024
buffer_load_dwordx4 v[120:123], v2, s[64:67], s55 offen offset:2048 sc1
buffer_load_dwordx4 v[124:127], v2, s[64:67], s54 offen offset:2048
buffer_load_dwordx4 v[128:131], v2, s[64:67], s56 offen offset:2048
buffer_load_dwordx4 v[132:135], v2, s[64:67], s55 offen offset:3072 sc1
buffer_load_dwordx4 v[136:139], v2, s[64:67], s54 offen offset:3072
buffer_load_dwordx4 v[140:143], v2, s[64:67], s56 offen offset:3072
s_add_u32 s54, s54, 4096
s_add_u32 s55, s55, 4096
s_add_u32 s56, s56, 4096
buffer_load_dwordx4 v[144:147], v2, s[64:67], s55 offen offset:0 sc1
buffer_load_dwordx4 v[148:151], v2, s[64:67], s54 offen offset:0
buffer_load_dwordx4 v[152:155], v2, s[64:67], s56 offen offset:0
v_lshrrev_b32 v13, 5, v0
v_lshlrev_b32 v13, 3, v13
v_and_b32 v12, 31, v0
v_mul_u32_u24 v14, 1152, v12
v_add_u32 v14, v14, v13
v_mul_u32_u24 v15, 4608, v12
v_lshl_add_u32 v15, v13, 1, v15
s_lshl_b32 s57, s3, 4
s_add_u32 s57, s57, 1024
s_mul_i32 s58, s4, 36864
s_add_u32 s58, s58, s57
s_mul_i32 s59, s4, 147456
s_lshl_b32 s60, s57, 1
s_add_u32 s59, s59, s60
s_mov_b32 s68, s16
s_and_b32 s69, s17, 0xffff
s_mov_b32 s70, 2359296
s_mov_b32 s71, 0x20000
s_mov_b32 s72, s32
s_and_b32 s73, s33, 0xffff
s_mov_b32 s74, 1152
s_mov_b32 s75, 0x20000
s_mov_b32 s92, s44
s_and_b32 s93, s45, 0xffff
s_mov_b32 s94, 9437184
s_mov_b32 s95, 0x20000
buffer_load_dwordx2 v[4:5], v14, s[68:71], s58 offen
buffer_load_dwordx2 v[6:7], v13, s[72:75], s57 offen
s_lshl_b32 s60, s3, 13
v_add_u32 v8, s60, v2
s_lshl_b32 s60, s3, 10
v_add_u32 v9, s60, v2
s_waitcnt vmcnt(26)
v_mfma_f32_32x32x16_bf16 v[16:31], v[52:55], v[48:51], 0
v_mfma_f32_32x32x16_bf16 v[32:47], v[56:59], v[48:51], 0
s_waitcnt vmcnt(23)
v_mfma_f32_32x32x16_bf16 v[16:31], v[64:67], v[60:63], v[16:31]
v_mfma_f32_32x32x16_bf16 v[32:47], v[68:71], v[60:63], v[32:47]
s_waitcnt vmcnt(20)
v_mfma_f32_32x32x16_bf16 v[16:31], v[76:79], v[72:75], v[16:31]
v_mfma_f32_32x32x16_bf16 v[32:47], v[80:83], v[72:75], v[32:47]
s_waitcnt vmcnt(17)
v_mfma_f32_32x32x16_bf16 v[16:31], v[88:91], v[84:87], v[16:31]
v_mfma_f32_32x32x16_bf16 v[32:47], v[92:95], v[84:87], v[32:47]
s_waitcnt vmcnt(14)
v_mfma_f32_32x32x16_bf16 v[16:31], v[100:103], v[96:99], v[16:31]
v_mfma_f32_32x32x16_bf16 v[32:47], v[104:107], v[96:99], v[32:47]
s_waitcnt vmcnt(11)
v_mfma_f32_32x32x16_bf16 v[16:31], v[112:115], v[108:111], v[16:31]
v_mfma_f32_32x32x16_bf16 v[32:47], v[116:119], v[108:111], v[32:47]
s_waitcnt vmcnt(8)
v_mfma_f32_32x32x16_bf16 v[16:31], v[124:127], v[120:123], v[16:31]
v_mfma_f32_32x32x16_bf16 v[32:47], v[128:131], v[120:123], v[32:47]
s_waitcnt vmcnt(5)
v_mfma_f32_32x32x16_bf16 v[16:31], v[136:139], v[132:135], v[16:31]
v_mfma_f32_32x32x16_bf16 v[32:47], v[140:143], v[132:135], v[32:47]
s_waitcnt vmcnt(2)
v_mfma_f32_32x32x16_bf16 v[16:31], v[148:151], v[144:147], v[16:31]
v_mfma_f32_32x32x16_bf16 v[32:47], v[152:155], v[144:147], v[32:47]
s_nop 10
ds_write_b128 v8, v[16:19] offset:0
ds_write_b128 v8, v[20:23] offset:1024
ds_write_b128 v8, v[24:27] offset:2048
ds_write_b128 v8, v[28:31] offset:3072
ds_write_b128 v8, v[32:35] offset:4096
ds_write_b128 v8, v[36:39] offset:5120
ds_write_b128 v8, v[40:43] offset:6144
ds_write_b128 v8, v[44:47] offset:7168
s_waitcnt lgkmcnt(0)
s_barrier
ds_read_b128 v[48:51], v9 offset:0
ds_read_b128 v[52:55], v9 offset:8192
ds_read_b128 v[56:59], v9 offset:16384
ds_read_b128 v[60:63], v9 offset:24576
ds_read_b128 v[64:67], v9 offset:32768
ds_read_b128 v[68:71], v9 offset:40960
ds_read_b128 v[72:75], v9 offset:49152
ds_read_b128 v[76:79], v9 offset:57344
s_waitcnt vmcnt(0)
v_and_b32 v10, 0xffff, v6
v_and_b32 v11, 0xffff0000, v6
v_dot2_f32_bf16 v16, v4, v10, 0
v_dot2_f32_bf16 v17, v4, v11, 0
v_and_b32 v10, 0xffff, v7
v_and_b32 v11, 0xffff0000, v7
v_dot2_f32_bf16 v18, v5, v10, 0
v_dot2_f32_bf16 v19, v5, v11, 0
s_waitcnt lgkmcnt(7)
v_pk_add_f32 v[16:17], v[16:17], v[48:49]
s_nop 0
v_pk_add_f32 v[18:19], v[18:19], v[50:51]
s_waitcnt lgkmcnt(6)
v_pk_add_f32 v[16:17], v[16:17], v[52:53]
v_pk_add_f32 v[18:19], v[18:19], v[54:55]
s_waitcnt lgkmcnt(5)
v_pk_add_f32 v[16:17], v[16:17], v[56:57]
v_pk_add_f32 v[18:19], v[18:19], v[58:59]
s_waitcnt lgkmcnt(4)
v_pk_add_f32 v[16:17], v[16:17], v[60:61]
v_pk_add_f32 v[18:19], v[18:19], v[62:63]
s_waitcnt lgkmcnt(3)
v_pk_add_f32 v[16:17], v[16:17], v[64:65]
v_pk_add_f32 v[18:19], v[18:19], v[66:67]
s_waitcnt lgkmcnt(2)
v_pk_add_f32 v[16:17], v[16:17], v[68:69]
v_pk_add_f32 v[18:19], v[18:19], v[70:71]
s_waitcnt lgkmcnt(1)
v_pk_add_f32 v[16:17], v[16:17], v[72:73]
v_pk_add_f32 v[18:19], v[18:19], v[74:75]
s_waitcnt lgkmcnt(0)
v_pk_add_f32 v[16:17], v[16:17], v[76:77]
v_pk_add_f32 v[18:19], v[18:19], v[78:79]
buffer_store_dwordx4 v[16:19], v15, s[92:95], s59 offen
k2_kernel_end:
s_endpgm
k2_slow:
v_mov_b32 v14, 0xff800000
s_mov_b32 s4, 0
k2_sp0:
s_lshl_b32 s13, s4, 13
s_lshl_b32 s14, s4, 14
s_add_u32 s14, s14, 81920
s_lshl_b32 s15, s4, 11
s_add_u32 s15, s15, 65536
buffer_load_dwordx4 v[16:19], v5, s[56:59], s15 offen
buffer_load_dwordx4 v[20:23], v5, s[56:59], s15 offen offset:1024
s_add_u32 s7, s13, 0
buffer_load_dwordx4 v[24:27], v5, s[56:59], s7 offen offset:0
s_add_u32 s7, s13, 0
buffer_load_dwordx4 v[28:31], v5, s[56:59], s7 offen offset:1024
s_add_u32 s7, s13, 0
buffer_load_dwordx4 v[32:35], v5, s[56:59], s7 offen offset:2048
s_add_u32 s7, s13, 0
buffer_load_dwordx4 v[36:39], v5, s[56:59], s7 offen offset:3072
s_add_u32 s7, s13, 4096
buffer_load_dwordx4 v[40:43], v5, s[56:59], s7 offen offset:0
s_add_u32 s7, s13, 4096
buffer_load_dwordx4 v[44:47], v5, s[56:59], s7 offen offset:1024
s_add_u32 s7, s13, 4096
buffer_load_dwordx4 v[48:51], v5, s[56:59], s7 offen offset:2048
s_add_u32 s7, s13, 4096
buffer_load_dwordx4 v[52:55], v5, s[56:59], s7 offen offset:3072
s_waitcnt vmcnt(0)
v_mfma_f32_32x32x8_bf16 v[120:135], v[16:17], v[196:197], 0
v_mfma_f32_32x32x16_bf16 v[120:135], v[24:27], v[192:195], v[120:135]
s_nop 11
v_max3_f32 v14, v14, v120, v121
v_max3_f32 v14, v14, v122, v123
v_max3_f32 v14, v14, v124, v125
v_max3_f32 v14, v14, v126, v127
v_max3_f32 v14, v14, v128, v129
v_max3_f32 v14, v14, v130, v131
v_max3_f32 v14, v14, v132, v133
v_max3_f32 v14, v14, v134, v135
v_mfma_f32_32x32x8_bf16 v[120:135], v[16:17], v[198:199], 0
v_mfma_f32_32x32x16_bf16 v[120:135], v[28:31], v[192:195], v[120:135]
s_nop 11
v_max3_f32 v14, v14, v120, v121
v_max3_f32 v14, v14, v122, v123
v_max3_f32 v14, v14, v124, v125
v_max3_f32 v14, v14, v126, v127
v_max3_f32 v14, v14, v128, v129
v_max3_f32 v14, v14, v130, v131
v_max3_f32 v14, v14, v132, v133
v_max3_f32 v14, v14, v134, v135
v_mfma_f32_32x32x8_bf16 v[120:135], v[18:19], v[196:197], 0
v_mfma_f32_32x32x16_bf16 v[120:135], v[32:35], v[192:195], v[120:135]
s_nop 11
v_max3_f32 v14, v14, v120, v121
v_max3_f32 v14, v14, v122, v123
v_max3_f32 v14, v14, v124, v125
v_max3_f32 v14, v14, v126, v127
v_max3_f32 v14, v14, v128, v129
v_max3_f32 v14, v14, v130, v131
v_max3_f32 v14, v14, v132, v133
v_max3_f32 v14, v14, v134, v135
v_mfma_f32_32x32x8_bf16 v[120:135], v[18:19], v[198:199], 0
v_mfma_f32_32x32x16_bf16 v[120:135], v[36:39], v[192:195], v[120:135]
s_nop 11
v_max3_f32 v14, v14, v120, v121
v_max3_f32 v14, v14, v122, v123
v_max3_f32 v14, v14, v124, v125
v_max3_f32 v14, v14, v126, v127
v_max3_f32 v14, v14, v128, v129
v_max3_f32 v14, v14, v130, v131
v_max3_f32 v14, v14, v132, v133
v_max3_f32 v14, v14, v134, v135
v_mfma_f32_32x32x8_bf16 v[120:135], v[20:21], v[196:197], 0
v_mfma_f32_32x32x16_bf16 v[120:135], v[40:43], v[192:195], v[120:135]
s_nop 11
v_max3_f32 v14, v14, v120, v121
v_max3_f32 v14, v14, v122, v123
v_max3_f32 v14, v14, v124, v125
v_max3_f32 v14, v14, v126, v127
v_max3_f32 v14, v14, v128, v129
v_max3_f32 v14, v14, v130, v131
v_max3_f32 v14, v14, v132, v133
v_max3_f32 v14, v14, v134, v135
v_mfma_f32_32x32x8_bf16 v[120:135], v[20:21], v[198:199], 0
v_mfma_f32_32x32x16_bf16 v[120:135], v[44:47], v[192:195], v[120:135]
s_nop 11
v_max3_f32 v14, v14, v120, v121
v_max3_f32 v14, v14, v122, v123
v_max3_f32 v14, v14, v124, v125
v_max3_f32 v14, v14, v126, v127
v_max3_f32 v14, v14, v128, v129
v_max3_f32 v14, v14, v130, v131
v_max3_f32 v14, v14, v132, v133
v_max3_f32 v14, v14, v134, v135
v_mfma_f32_32x32x8_bf16 v[120:135], v[22:23], v[196:197], 0
v_mfma_f32_32x32x16_bf16 v[120:135], v[48:51], v[192:195], v[120:135]
s_nop 11
v_max3_f32 v14, v14, v120, v121
v_max3_f32 v14, v14, v122, v123
v_max3_f32 v14, v14, v124, v125
v_max3_f32 v14, v14, v126, v127
v_max3_f32 v14, v14, v128, v129
v_max3_f32 v14, v14, v130, v131
v_max3_f32 v14, v14, v132, v133
v_max3_f32 v14, v14, v134, v135
v_mfma_f32_32x32x8_bf16 v[120:135], v[22:23], v[198:199], 0
v_mfma_f32_32x32x16_bf16 v[120:135], v[52:55], v[192:195], v[120:135]
s_nop 11
v_max3_f32 v14, v14, v120, v121
v_max3_f32 v14, v14, v122, v123
v_max3_f32 v14, v14, v124, v125
v_max3_f32 v14, v14, v126, v127
v_max3_f32 v14, v14, v128, v129
v_max3_f32 v14, v14, v130, v131
v_max3_f32 v14, v14, v132, v133
v_max3_f32 v14, v14, v134, v135
s_add_u32 s4, s4, 1
s_cmp_lt_u32 s4, 8
s_cbranch_scc1 k2_sp0
v_mov_b32 v15, v14
s_nop 1
v_permlane32_swap_b32 v14, v15
v_max_f32 v14, v14, v15
v_sub_f32 v136, 0, v14
v_mov_b32 v168, 0
v_sub_f32 v137, 0, v14
v_mov_b32 v169, 0
v_sub_f32 v138, 0, v14
v_mov_b32 v170, 0
v_sub_f32 v139, 0, v14
v_mov_b32 v171, 0
v_sub_f32 v140, 0, v14
v_mov_b32 v172, 0
v_sub_f32 v141, 0, v14
v_mov_b32 v173, 0
v_sub_f32 v142, 0, v14
v_mov_b32 v174, 0
v_sub_f32 v143, 0, v14
v_mov_b32 v175, 0
v_sub_f32 v144, 0, v14
v_mov_b32 v176, 0
v_sub_f32 v145, 0, v14
v_mov_b32 v177, 0
v_sub_f32 v146, 0, v14
v_mov_b32 v178, 0
v_sub_f32 v147, 0, v14
v_mov_b32 v179, 0
v_sub_f32 v148, 0, v14
v_mov_b32 v180, 0
v_sub_f32 v149, 0, v14
v_mov_b32 v181, 0
v_sub_f32 v150, 0, v14
v_mov_b32 v182, 0
v_sub_f32 v151, 0, v14
v_mov_b32 v183, 0
s_mov_b32 s4, 0
k2_sp1:
s_lshl_b32 s13, s4, 13
s_lshl_b32 s14, s4, 14
s_add_u32 s14, s14, 81920
s_lshl_b32 s15, s4, 11
s_add_u32 s15, s15, 65536
buffer_load_dwordx4 v[16:19], v5, s[56:59], s15 offen
buffer_load_dwordx4 v[20:23], v5, s[56:59], s15 offen offset:1024
s_add_u32 s7, s13, 0
buffer_load_dwordx4 v[24:27], v5, s[56:59], s7 offen offset:0
s_add_u32 s7, s14, 0
buffer_load_dwordx4 v[56:59], v6, s[56:59], s7 offen offset:0
buffer_load_dwordx4 v[60:63], v6, s[56:59], s7 offen offset:1024
s_add_u32 s7, s13, 0
buffer_load_dwordx4 v[28:31], v5, s[56:59], s7 offen offset:1024
s_add_u32 s7, s14, 0
buffer_load_dwordx4 v[64:67], v6, s[56:59], s7 offen offset:2048
buffer_load_dwordx4 v[68:71], v6, s[56:59], s7 offen offset:3072
s_add_u32 s7, s13, 0
buffer_load_dwordx4 v[32:35], v5, s[56:59], s7 offen offset:2048
s_add_u32 s7, s14, 4096
buffer_load_dwordx4 v[72:75], v6, s[56:59], s7 offen offset:0
buffer_load_dwordx4 v[76:79], v6, s[56:59], s7 offen offset:1024
s_add_u32 s7, s13, 0
buffer_load_dwordx4 v[36:39], v5, s[56:59], s7 offen offset:3072
s_add_u32 s7, s14, 4096
buffer_load_dwordx4 v[80:83], v6, s[56:59], s7 offen offset:2048
buffer_load_dwordx4 v[84:87], v6, s[56:59], s7 offen offset:3072
s_add_u32 s7, s13, 4096
buffer_load_dwordx4 v[40:43], v5, s[56:59], s7 offen offset:0
s_add_u32 s7, s14, 8192
buffer_load_dwordx4 v[88:91], v6, s[56:59], s7 offen offset:0
buffer_load_dwordx4 v[92:95], v6, s[56:59], s7 offen offset:1024
s_add_u32 s7, s13, 4096
buffer_load_dwordx4 v[44:47], v5, s[56:59], s7 offen offset:1024
s_add_u32 s7, s14, 8192
buffer_load_dwordx4 v[96:99], v6, s[56:59], s7 offen offset:2048
buffer_load_dwordx4 v[100:103], v6, s[56:59], s7 offen offset:3072
s_add_u32 s7, s13, 4096
buffer_load_dwordx4 v[48:51], v5, s[56:59], s7 offen offset:2048
s_add_u32 s7, s14, 12288
buffer_load_dwordx4 v[104:107], v6, s[56:59], s7 offen offset:0
buffer_load_dwordx4 v[108:111], v6, s[56:59], s7 offen offset:1024
s_add_u32 s7, s13, 4096
buffer_load_dwordx4 v[52:55], v5, s[56:59], s7 offen offset:3072
s_add_u32 s7, s14, 12288
buffer_load_dwordx4 v[112:115], v6, s[56:59], s7 offen offset:2048
buffer_load_dwordx4 v[116:119], v6, s[56:59], s7 offen offset:3072
s_waitcnt vmcnt(0)
v_mfma_f32_32x32x8_bf16 v[120:135], v[16:17], v[196:197], v[136:151]
v_mfma_f32_32x32x16_bf16 v[120:135], v[24:27], v[192:195], v[120:135]
s_nop 11
v_exp_f32 v120, v120
v_exp_f32 v121, v121
v_exp_f32 v122, v122
v_exp_f32 v123, v123
v_exp_f32 v124, v124
v_exp_f32 v125, v125
v_exp_f32 v126, v126
v_exp_f32 v127, v127
v_exp_f32 v128, v128
v_exp_f32 v129, v129
v_exp_f32 v130, v130
v_exp_f32 v131, v131
v_exp_f32 v132, v132
v_exp_f32 v133, v133
v_exp_f32 v134, v134
v_exp_f32 v135, v135
v_cvt_pk_bf16_f32 v120, v120, v121
v_cvt_pk_bf16_f32 v121, v122, v123
v_cvt_pk_bf16_f32 v122, v124, v125
v_cvt_pk_bf16_f32 v123, v126, v127
v_cvt_pk_bf16_f32 v124, v128, v129
v_cvt_pk_bf16_f32 v125, v130, v131
v_cvt_pk_bf16_f32 v126, v132, v133
v_cvt_pk_bf16_f32 v127, v134, v135
v_mfma_f32_32x32x16_bf16 v[168:183], v[56:59], v[120:123], v[168:183]
s_nop 0
v_mfma_f32_32x32x16_bf16 v[168:183], v[60:63], v[124:127], v[168:183]
v_mfma_f32_32x32x8_bf16 v[120:135], v[16:17], v[198:199], v[136:151]
v_mfma_f32_32x32x16_bf16 v[120:135], v[28:31], v[192:195], v[120:135]
s_nop 11
v_exp_f32 v120, v120
v_exp_f32 v121, v121
v_exp_f32 v122, v122
v_exp_f32 v123, v123
v_exp_f32 v124, v124
v_exp_f32 v125, v125
v_exp_f32 v126, v126
v_exp_f32 v127, v127
v_exp_f32 v128, v128
v_exp_f32 v129, v129
v_exp_f32 v130, v130
v_exp_f32 v131, v131
v_exp_f32 v132, v132
v_exp_f32 v133, v133
v_exp_f32 v134, v134
v_exp_f32 v135, v135
v_cvt_pk_bf16_f32 v120, v120, v121
v_cvt_pk_bf16_f32 v121, v122, v123
v_cvt_pk_bf16_f32 v122, v124, v125
v_cvt_pk_bf16_f32 v123, v126, v127
v_cvt_pk_bf16_f32 v124, v128, v129
v_cvt_pk_bf16_f32 v125, v130, v131
v_cvt_pk_bf16_f32 v126, v132, v133
v_cvt_pk_bf16_f32 v127, v134, v135
v_mfma_f32_32x32x16_bf16 v[168:183], v[64:67], v[120:123], v[168:183]
s_nop 0
v_mfma_f32_32x32x16_bf16 v[168:183], v[68:71], v[124:127], v[168:183]
v_mfma_f32_32x32x8_bf16 v[120:135], v[18:19], v[196:197], v[136:151]
v_mfma_f32_32x32x16_bf16 v[120:135], v[32:35], v[192:195], v[120:135]
s_nop 11
v_exp_f32 v120, v120
v_exp_f32 v121, v121
v_exp_f32 v122, v122
v_exp_f32 v123, v123
v_exp_f32 v124, v124
v_exp_f32 v125, v125
v_exp_f32 v126, v126
v_exp_f32 v127, v127
v_exp_f32 v128, v128
v_exp_f32 v129, v129
v_exp_f32 v130, v130
v_exp_f32 v131, v131
v_exp_f32 v132, v132
v_exp_f32 v133, v133
v_exp_f32 v134, v134
v_exp_f32 v135, v135
v_cvt_pk_bf16_f32 v120, v120, v121
v_cvt_pk_bf16_f32 v121, v122, v123
v_cvt_pk_bf16_f32 v122, v124, v125
v_cvt_pk_bf16_f32 v123, v126, v127
v_cvt_pk_bf16_f32 v124, v128, v129
v_cvt_pk_bf16_f32 v125, v130, v131
v_cvt_pk_bf16_f32 v126, v132, v133
v_cvt_pk_bf16_f32 v127, v134, v135
v_mfma_f32_32x32x16_bf16 v[168:183], v[72:75], v[120:123], v[168:183]
s_nop 0
v_mfma_f32_32x32x16_bf16 v[168:183], v[76:79], v[124:127], v[168:183]
v_mfma_f32_32x32x8_bf16 v[120:135], v[18:19], v[198:199], v[136:151]
v_mfma_f32_32x32x16_bf16 v[120:135], v[36:39], v[192:195], v[120:135]
s_nop 11
v_exp_f32 v120, v120
v_exp_f32 v121, v121
v_exp_f32 v122, v122
v_exp_f32 v123, v123
v_exp_f32 v124, v124
v_exp_f32 v125, v125
v_exp_f32 v126, v126
v_exp_f32 v127, v127
v_exp_f32 v128, v128
v_exp_f32 v129, v129
v_exp_f32 v130, v130
v_exp_f32 v131, v131
v_exp_f32 v132, v132
v_exp_f32 v133, v133
v_exp_f32 v134, v134
v_exp_f32 v135, v135
v_cvt_pk_bf16_f32 v120, v120, v121
v_cvt_pk_bf16_f32 v121, v122, v123
v_cvt_pk_bf16_f32 v122, v124, v125
v_cvt_pk_bf16_f32 v123, v126, v127
v_cvt_pk_bf16_f32 v124, v128, v129
v_cvt_pk_bf16_f32 v125, v130, v131
v_cvt_pk_bf16_f32 v126, v132, v133
v_cvt_pk_bf16_f32 v127, v134, v135
v_mfma_f32_32x32x16_bf16 v[168:183], v[80:83], v[120:123], v[168:183]
s_nop 0
v_mfma_f32_32x32x16_bf16 v[168:183], v[84:87], v[124:127], v[168:183]
v_mfma_f32_32x32x8_bf16 v[120:135], v[20:21], v[196:197], v[136:151]
v_mfma_f32_32x32x16_bf16 v[120:135], v[40:43], v[192:195], v[120:135]
s_nop 11
v_exp_f32 v120, v120
v_exp_f32 v121, v121
v_exp_f32 v122, v122
v_exp_f32 v123, v123
v_exp_f32 v124, v124
v_exp_f32 v125, v125
v_exp_f32 v126, v126
v_exp_f32 v127, v127
v_exp_f32 v128, v128
v_exp_f32 v129, v129
v_exp_f32 v130, v130
v_exp_f32 v131, v131
v_exp_f32 v132, v132
v_exp_f32 v133, v133
v_exp_f32 v134, v134
v_exp_f32 v135, v135
v_cvt_pk_bf16_f32 v120, v120, v121
v_cvt_pk_bf16_f32 v121, v122, v123
v_cvt_pk_bf16_f32 v122, v124, v125
v_cvt_pk_bf16_f32 v123, v126, v127
v_cvt_pk_bf16_f32 v124, v128, v129
v_cvt_pk_bf16_f32 v125, v130, v131
v_cvt_pk_bf16_f32 v126, v132, v133
v_cvt_pk_bf16_f32 v127, v134, v135
v_mfma_f32_32x32x16_bf16 v[168:183], v[88:91], v[120:123], v[168:183]
s_nop 0
v_mfma_f32_32x32x16_bf16 v[168:183], v[92:95], v[124:127], v[168:183]
v_mfma_f32_32x32x8_bf16 v[120:135], v[20:21], v[198:199], v[136:151]
v_mfma_f32_32x32x16_bf16 v[120:135], v[44:47], v[192:195], v[120:135]
s_nop 11
v_exp_f32 v120, v120
v_exp_f32 v121, v121
v_exp_f32 v122, v122
v_exp_f32 v123, v123
v_exp_f32 v124, v124
v_exp_f32 v125, v125
v_exp_f32 v126, v126
v_exp_f32 v127, v127
v_exp_f32 v128, v128
v_exp_f32 v129, v129
v_exp_f32 v130, v130
v_exp_f32 v131, v131
v_exp_f32 v132, v132
v_exp_f32 v133, v133
v_exp_f32 v134, v134
v_exp_f32 v135, v135
v_cvt_pk_bf16_f32 v120, v120, v121
v_cvt_pk_bf16_f32 v121, v122, v123
v_cvt_pk_bf16_f32 v122, v124, v125
v_cvt_pk_bf16_f32 v123, v126, v127
v_cvt_pk_bf16_f32 v124, v128, v129
v_cvt_pk_bf16_f32 v125, v130, v131
v_cvt_pk_bf16_f32 v126, v132, v133
v_cvt_pk_bf16_f32 v127, v134, v135
v_mfma_f32_32x32x16_bf16 v[168:183], v[96:99], v[120:123], v[168:183]
s_nop 0
v_mfma_f32_32x32x16_bf16 v[168:183], v[100:103], v[124:127], v[168:183]
v_mfma_f32_32x32x8_bf16 v[120:135], v[22:23], v[196:197], v[136:151]
v_mfma_f32_32x32x16_bf16 v[120:135], v[48:51], v[192:195], v[120:135]
s_nop 11
v_exp_f32 v120, v120
v_exp_f32 v121, v121
v_exp_f32 v122, v122
v_exp_f32 v123, v123
v_exp_f32 v124, v124
v_exp_f32 v125, v125
v_exp_f32 v126, v126
v_exp_f32 v127, v127
v_exp_f32 v128, v128
v_exp_f32 v129, v129
v_exp_f32 v130, v130
v_exp_f32 v131, v131
v_exp_f32 v132, v132
v_exp_f32 v133, v133
v_exp_f32 v134, v134
v_exp_f32 v135, v135
v_cvt_pk_bf16_f32 v120, v120, v121
v_cvt_pk_bf16_f32 v121, v122, v123
v_cvt_pk_bf16_f32 v122, v124, v125
v_cvt_pk_bf16_f32 v123, v126, v127
v_cvt_pk_bf16_f32 v124, v128, v129
v_cvt_pk_bf16_f32 v125, v130, v131
v_cvt_pk_bf16_f32 v126, v132, v133
v_cvt_pk_bf16_f32 v127, v134, v135
v_mfma_f32_32x32x16_bf16 v[168:183], v[104:107], v[120:123], v[168:183]
s_nop 0
v_mfma_f32_32x32x16_bf16 v[168:183], v[108:111], v[124:127], v[168:183]
v_mfma_f32_32x32x8_bf16 v[120:135], v[22:23], v[198:199], v[136:151]
v_mfma_f32_32x32x16_bf16 v[120:135], v[52:55], v[192:195], v[120:135]
s_nop 11
v_exp_f32 v120, v120
v_exp_f32 v121, v121
v_exp_f32 v122, v122
v_exp_f32 v123, v123
v_exp_f32 v124, v124
v_exp_f32 v125, v125
v_exp_f32 v126, v126
v_exp_f32 v127, v127
v_exp_f32 v128, v128
v_exp_f32 v129, v129
v_exp_f32 v130, v130
v_exp_f32 v131, v131
v_exp_f32 v132, v132
v_exp_f32 v133, v133
v_exp_f32 v134, v134
v_exp_f32 v135, v135
v_cvt_pk_bf16_f32 v120, v120, v121
v_cvt_pk_bf16_f32 v121, v122, v123
v_cvt_pk_bf16_f32 v122, v124, v125
v_cvt_pk_bf16_f32 v123, v126, v127
v_cvt_pk_bf16_f32 v124, v128, v129
v_cvt_pk_bf16_f32 v125, v130, v131
v_cvt_pk_bf16_f32 v126, v132, v133
v_cvt_pk_bf16_f32 v127, v134, v135
v_mfma_f32_32x32x16_bf16 v[168:183], v[112:115], v[120:123], v[168:183]
s_nop 0
v_mfma_f32_32x32x16_bf16 v[168:183], v[116:119], v[124:127], v[168:183]
s_add_u32 s4, s4, 1
s_cmp_lt_u32 s4, 8
s_cbranch_scc1 k2_sp1
s_nop 8
v_mov_b32 v14, v176
v_mov_b32 v15, v176
s_nop 1
v_permlane32_swap_b32 v14, v15
s_mov_b32 s100, 1
s_branch k2_fin
.p2align 8
s_endpgm
s_endpgm
s_endpgm
s_endpgm
.fill 4096, 4, 0xbf810000
.section .rodata,"a"
.p2align 6
.amdhsa_kernel k1_kernel
  .amdhsa_next_free_vgpr 168
  .amdhsa_next_free_sgpr 102
  .amdhsa_accum_offset 168
  .amdhsa_group_segment_fixed_size 0
  .amdhsa_kernarg_size 136
  .amdhsa_user_sgpr_count 2
  .amdhsa_user_sgpr_kernarg_segment_ptr 1
  .amdhsa_system_sgpr_workgroup_id_x 1
.end_amdhsa_kernel
.p2align 6
.amdhsa_kernel k2_kernel
  .amdhsa_next_free_vgpr 256
  .amdhsa_next_free_sgpr 102
  .amdhsa_accum_offset 256
  .amdhsa_group_segment_fixed_size 0
  .amdhsa_kernarg_size 136
  .amdhsa_user_sgpr_count 2
  .amdhsa_user_sgpr_kernarg_segment_ptr 1
  .amdhsa_system_sgpr_workgroup_id_x 1
.end_amdhsa_kernel
```
